```python
import torch

def _softmax(x, axis=-1):
    return torch.softmax(x, dim=axis)
def _gelu(x):
    return torch.nn.functional.gelu(x, approximate="tanh")
def _silu(x):
    return torch.nn.functional.silu(x)
def _sigmoid(x):
    return torch.sigmoid(x)
def _layernorm(x, axis=-1, eps=1e-5):
    m = x.mean(dim=axis, keepdim=True)
    v = x.var(dim=axis, keepdim=True, unbiased=False)
    return (x - m) / torch.sqrt(v + eps)
def _scatter_add(tgt, idx, src, axis=0):
    return tgt.clone().index_add_(axis, idx, src)
def _segment_sum(src, seg, n):
    out = torch.zeros((n,) + src.shape[1:], dtype=src.dtype)
    return out.index_add_(0, seg, src)
def _pad(x, pw):
    flat = tuple(v for pair in reversed(pw) for v in pair)
    return torch.nn.functional.pad(x, flat)

kernel_name = 'standalone__softmax_full_bidir__sampling'

def setup_inputs():

    _w = (lambda a: (lambda t: t.to(torch.bfloat16) if t.is_floating_point() else t)(torch.as_tensor(a)))
    B, H, Sq, Skv, Dh = 8, 16, 4, 8192, 256
    return {
        "q": _w((lambda *s: torch.randn(*s, dtype=torch.bfloat16) * 0.8)(B, H, Sq, Dh)),
        "k": _w((lambda *s: torch.randn(*s, dtype=torch.bfloat16) * 0.8)(B, H, Skv, Dh)),
        "v": _w((lambda *s: torch.randn(*s, dtype=torch.bfloat16) * 0.05)(B, H, Skv, Dh)),
    }

def reference(q, k, v):
    scale = q.shape[-1] ** -0.5
    scores = torch.einsum('bhqd,bhkd->bhqk', q, k) * scale
    attn = _softmax(scores, axis=-1)
    return torch.einsum('bhqk,bhkd->bhqd', attn, v)
```

```asm
; @launch grid=(256,1,1) block=(192,1,1) lds=69648
.amdgcn_target "amdgcn-amd-amdhsa--gfx950"
.text
.p2align 12
.fill 832, 4, 0xbf810000
.globl standalone__softmax_full_bidir__sampling_kernel
.p2align 8
.type standalone__softmax_full_bidir__sampling_kernel,@function
standalone__softmax_full_bidir__sampling_kernel:
  s_cmpk_ge_u32 s2, 256
  s_cbranch_scc1 L_done
  s_load_dwordx8 s[4:11], s[0:1], 0
  s_load_dwordx4 s[12:15], s[0:1], 32
  v_lshrrev_b32 v7, 6, v0
  v_and_b32 v0, 63, v0
  v_readfirstlane_b32 s3, v7
  s_cmp_eq_u32 s3, 2
  s_cbranch_scc1 L_helper
  v_and_b32 v8, 3, v0
  v_lshlrev_b32 v8, 2, v8
  v_and_or_b32 v8, v0, 48, v8
  v_and_b32 v6, 32, v0
  v_lshl_or_b32 v8, v6, 1, v8
  v_lshlrev_b32 v6, 6, v7
  v_xor_b32 v8, v8, v6
  v_lshlrev_b32 v8, 2, v8
  s_lshr_b32 s30, s2, 1
  s_lshl_b32 s30, s30, 11
  v_and_b32 v6, 12, v0
  v_lshl_or_b32 v9, v6, 7, v8
  v_or_b32 v9, s30, v9
  v_xor_b32 v10, 0x100, v9
  v_and_b32 v6, 4, v0
  v_lshl_or_b32 v8, v6, 14, v8
  v_and_b32 v6, 8, v0
  v_lshl_or_b32 v8, v6, 9, v8
  s_mul_i32 s29, s3, 0x3000
  s_bitcmp1_b32 s2, 0
  s_cselect_b32 s26, 0x8000, 0
  s_xor_b32 s29, s29, s26
  s_bitcmp1_b32 s2, 1
  s_cselect_b32 s26, 0x9800, 0
  s_xor_b32 s29, s29, s26
  s_bitcmp1_b32 s2, 2
  s_cselect_b32 s26, 0x122600, 0
  s_xor_b32 s29, s29, s26
  s_bitcmp1_b32 s2, 3
  s_cselect_b32 s26, 0x120800, 0
  s_xor_b32 s29, s29, s26
  s_bitcmp1_b32 s2, 4
  s_cselect_b32 s26, 0x88200, 0
  s_xor_b32 s29, s29, s26
  s_bitcmp1_b32 s2, 5
  s_cselect_b32 s26, 0x1d9200, 0
  s_xor_b32 s29, s29, s26
  s_bitcmp1_b32 s2, 6
  s_cselect_b32 s26, 0x81800, 0
  s_xor_b32 s29, s29, s26
  s_bitcmp1_b32 s2, 7
  s_cselect_b32 s26, 0x61200, 0
  s_xor_b32 s29, s29, s26
  v_xor_b32 v16, s29, v8
  s_lshl_b32 s28, s2, 21
  s_lshl_b32 s18, 1, 21
  s_mov_b32 s19, 0x20000
  s_waitcnt lgkmcnt(0)
  s_add_u32 s16, s6, s28
  s_addc_u32 s17, s7, 0
  global_load_dwordx4 v[24:27], v9, s[4:5]
  global_load_dwordx4 v[28:31], v10, s[4:5]
  buffer_load_dwordx4 v[84:87], v16, s[16:19], 0 offen nt
  v_xor_b32 v18, 0x1200, v16
  buffer_load_dwordx4 v[88:91], v18, s[16:19], 0 offen nt
  v_xor_b32 v17, 0x1a00, v16
  buffer_load_dwordx4 v[92:95], v17, s[16:19], 0 offen nt
  v_xor_b32 v18, 0x800, v16
  buffer_load_dwordx4 v[96:99], v18, s[16:19], 0 offen nt
  v_xor_b32 v17, 0x1d7a00, v16
  buffer_load_dwordx4 v[100:103], v17, s[16:19], 0 offen nt
  v_xor_b32 v18, 0x1d6800, v16
  buffer_load_dwordx4 v[104:107], v18, s[16:19], 0 offen nt
  v_xor_b32 v17, 0x1d6000, v16
  buffer_load_dwordx4 v[108:111], v17, s[16:19], 0 offen nt
  v_xor_b32 v18, 0x1d7200, v16
  buffer_load_dwordx4 v[112:115], v18, s[16:19], 0 offen nt
  v_xor_b32 v17, 0x100, v16
  buffer_load_dwordx4 v[116:119], v17, s[16:19], 0 offen nt
  v_xor_b32 v18, 0x1300, v16
  buffer_load_dwordx4 v[120:123], v18, s[16:19], 0 offen nt
  v_xor_b32 v17, 0x1b00, v16
  buffer_load_dwordx4 v[124:127], v17, s[16:19], 0 offen nt
  v_mov_b32 v1, v16
  s_mov_b32 s24, 1
  s_mov_b32 s25, 1
  s_mov_b32 s31, 0x8a00
  s_add_u32 s20, s8, s28
  s_addc_u32 s21, s9, 0
  s_mov_b32 s22, 0x200000
  s_mov_b32 s23, 0x20000
  v_and_b32 v2, 7, v0
  v_lshlrev_b32 v2, 4, v2
  v_bfe_i32 v6, v0, 3, 1
  v_and_b32 v6, 0x180, v6
  v_xor_b32 v2, v2, v6
  v_bfe_i32 v6, v0, 4, 1
  v_and_b32 v6, 0x10000, v6
  v_xor_b32 v2, v2, v6
  v_bfe_i32 v6, v0, 5, 1
  v_and_b32 v6, 0x1000, v6
  v_xor_b32 v2, v2, v6
  v_bfe_i32 v6, v7, 0, 1
  v_and_b32 v6, 0x100, v6
  v_xor_b32 v2, v2, v6
  v_xor_b32 v2, s29, v2
  v_and_b32 v46, 15, v0
  v_lshlrev_b32 v46, 3, v46
  v_bfe_i32 v6, v0, 4, 1
  v_and_b32 v6, 0x180, v6
  v_xor_b32 v46, v46, v6
  v_bfe_i32 v6, v0, 5, 1
  v_and_b32 v6, 0x200, v6
  v_xor_b32 v46, v46, v6
  s_and_b32 s27, s2, 1
  s_mul_i32 s26, s27, 256
  v_xor_b32 v46, s26, v46
  s_lshl_b32 s26, s3, 10
  v_lshl_add_u32 v47, v0, 4, s26
  s_add_u32 s26, s26, s30
  v_add_u32 v46, s26, v46
  s_lshl_b32 s26, s3, 11
  v_lshl_add_u32 v45, v0, 5, s26
  s_cmp_eq_u32 s27, s3
  s_cselect_b64 s[44:45], -1, 0
  s_mul_i32 s46, s3, 0x8a00
  s_xor_b32 s46, s46, 0xfd200
  s_mov_b32 s39, 0
  s_mov_b32 s47, 1024
  s_mov_b32 s36, 0x3db8aa3b
  v_and_b32 v5, 1, v0
  v_lshlrev_b32 v5, 4, v5
  v_mov_b32 v6, 0xffff
  v_lshlrev_b32 v5, v5, v6
  v_and_b32 v6, 2, v0
  v_cmp_eq_u32 vcc, 0, v6
  v_lshlrev_b32 v41, 2, v0
  v_and_b32 v40, -16, v41
  v_cndmask_b32 v3, 0, v5, vcc
  v_cndmask_b32 v4, v5, 0, vcc
  v_lshlrev_b32 v6, 9, v7
  v_add_u32 v40, v6, v40
  v_add_u32 v41, 512, v41
  v_sub_u32 v19, v41, v6
  v_add_u32 v41, v6, v41
  v_mov_b32 v5, 0xff800000
  v_mov_b32 v7, 0
  v_mov_b32 v11, 0
  v_mov_b32 v32, 0
  v_mov_b32 v33, 0
  v_mov_b32 v34, 0
  v_mov_b32 v35, 0
  v_mov_b32 v36, 0
  v_mov_b32 v37, 0
  v_mov_b32 v38, 0
  v_mov_b32 v39, 0
  s_getreg_b32 s26, hwreg(HW_REG_XCC_ID)
  s_bitcmp0_b32 s26, 0
  s_cselect_b32 s38, 35, 0
  s_add_u32 s38, s38, 275
  s_lshl_b32 s38, s38, 16
  s_lshl_b32 s37, s2, 16
  v_mov_b32 v22, 69632
  v_xor_b32 v18, 0x900, v16
  s_waitcnt vmcnt(10)
  buffer_load_dwordx4 v[128:131], v18, s[16:19], 0 offen nt
  v_xor_b32 v17, 0x1d7b00, v16
  s_waitcnt vmcnt(10)
  buffer_load_dwordx4 v[132:135], v17, s[16:19], 0 offen nt
  v_xor_b32 v18, 0x1d6900, v16
  s_waitcnt vmcnt(10)
  buffer_load_dwordx4 v[136:139], v18, s[16:19], 0 offen nt
  v_xor_b32 v17, 0x1d6100, v16
  s_waitcnt vmcnt(10)
  buffer_load_dwordx4 v[140:143], v17, s[16:19], 0 offen nt
  v_mfma_f32_16x16x32_bf16 v[52:55], v[84:87], v[24:27], 0
  v_xor_b32 v18, 0x1d7300, v16
  s_waitcnt vmcnt(10)
  buffer_load_dwordx4 v[144:147], v18, s[16:19], 0 offen nt
  v_mfma_f32_16x16x32_bf16 v[56:59], v[88:91], v[24:27], 0
  s_mov_b32 s29, 63
L_k:
  v_add_u32 v40, 1024, v40
  v_xor_b32 v16, s31, v1
  s_barrier
  s_and_b32 s37, s37, 0xffffff
  s_add_u32 s37, s37, s38
  s_lshr_b32 s26, s37, 24
  s_cmp_eq_u32 s26, 2
  s_cbranch_scc1 L_k_2
  s_cmp_eq_u32 s26, 0
  s_cbranch_scc1 L_k_0
L_k_1:
  s_waitcnt vmcnt(9)
  buffer_load_dwordx4 v[84:87], v16, s[16:19], 0 offen nt
  v_mfma_f32_16x16x32_bf16 v[60:63], v[92:95], v[24:27], 0
  v_xor_b32 v18, 0x1200, v16
  s_waitcnt vmcnt(9)
  buffer_load_dwordx4 v[88:91], v18, s[16:19], 0 offen nt
  s_add_u32 s25, s25, s24
  v_mfma_f32_16x16x32_bf16 v[64:67], v[96:99], v[24:27], 0
  v_xor_b32 v17, 0x1a00, v16
  s_waitcnt vmcnt(9)
  buffer_load_dwordx4 v[92:95], v17, s[16:19], 0 offen nt
  s_bitcmp1_b32 s25, 0
  s_cselect_b32 s31, 0x8a00, 0
  v_mfma_f32_16x16x32_bf16 v[68:71], v[100:103], v[24:27], 0
  v_xor_b32 v18, 0x800, v16
  s_waitcnt vmcnt(9)
  buffer_load_dwordx4 v[96:99], v18, s[16:19], 0 offen nt
  s_bitcmp1_b32 s25, 1
  s_cselect_b32 s26, 0xc9a00, 0
  s_xor_b32 s31, s31, s26
  v_mfma_f32_16x16x32_bf16 v[72:75], v[104:107], v[24:27], 0
  v_xor_b32 v17, 0x1d7a00, v16
  s_waitcnt vmcnt(9)
  buffer_load_dwordx4 v[100:103], v17, s[16:19], 0 offen nt
  s_bitcmp1_b32 s25, 2
  s_cselect_b32 s26, 0xd4c00, 0
  s_xor_b32 s31, s31, s26
  v_mfma_f32_16x16x32_bf16 v[76:79], v[108:111], v[24:27], 0
  v_xor_b32 v18, 0x1d6800, v16
  s_waitcnt vmcnt(9)
  buffer_load_dwordx4 v[104:107], v18, s[16:19], 0 offen nt
  s_bitcmp1_b32 s25, 3
  s_cselect_b32 s26, 0x40000, 0
  s_xor_b32 s31, s31, s26
  v_mfma_f32_16x16x32_bf16 v[80:83], v[112:115], v[24:27], 0
  v_xor_b32 v17, 0x1d6000, v16
  s_waitcnt vmcnt(9)
  buffer_load_dwordx4 v[108:111], v17, s[16:19], 0 offen nt
  s_bitcmp1_b32 s25, 4
  s_cselect_b32 s26, 0x157400, 0
  s_xor_b32 s31, s31, s26
  v_mfma_f32_16x16x32_bf16 v[52:55], v[116:119], v[28:31], v[52:55]
  v_xor_b32 v18, 0x1d7200, v16
  s_waitcnt vmcnt(9)
  buffer_load_dwordx4 v[112:115], v18, s[16:19], 0 offen nt
  s_bitcmp1_b32 s25, 5
  s_cselect_b32 s26, 0x13ea00, 0
  s_xor_b32 s31, s31, s26
  v_mfma_f32_16x16x32_bf16 v[56:59], v[120:123], v[28:31], v[56:59]
  s_nop 4
  v_mov_b32_dpp v9, v52 quad_perm:[0,0,0,0] row_mask:0xf bank_mask:0xf
  v_mov_b32_dpp v10, v54 quad_perm:[2,2,2,2] row_mask:0xf bank_mask:0xf
  s_nop 0
  v_add_f32_dpp v9, v53, v9 quad_perm:[1,1,1,1] row_mask:0xf bank_mask:0xf
  v_add_f32_dpp v10, v55, v10 quad_perm:[3,3,3,3] row_mask:0xf bank_mask:0xf
  v_add_f32 v8, v9, v10
  v_max_f32 v5, v5, v8
  ds_write_b32 v40, v8 offset:1024
  v_xor_b32 v17, 0x100, v16
  s_waitcnt vmcnt(9)
  buffer_load_dwordx4 v[116:119], v17, s[16:19], 0 offen nt
  v_mfma_f32_16x16x32_bf16 v[60:63], v[124:127], v[28:31], v[60:63]
  v_mov_b32_dpp v9, v56 quad_perm:[0,0,0,0] row_mask:0xf bank_mask:0xf
  v_mov_b32_dpp v10, v58 quad_perm:[2,2,2,2] row_mask:0xf bank_mask:0xf
  s_nop 0
  v_add_f32_dpp v9, v57, v9 quad_perm:[1,1,1,1] row_mask:0xf bank_mask:0xf
  v_add_f32_dpp v10, v59, v10 quad_perm:[3,3,3,3] row_mask:0xf bank_mask:0xf
  v_add_f32 v8, v9, v10
  v_max_f32 v5, v5, v8
  ds_write_b32 v40, v8 offset:1028
  v_xor_b32 v18, 0x1300, v16
  s_waitcnt vmcnt(9)
  buffer_load_dwordx4 v[120:123], v18, s[16:19], 0 offen nt
  v_mfma_f32_16x16x32_bf16 v[64:67], v[128:131], v[28:31], v[64:67]
  v_mov_b32_dpp v9, v60 quad_perm:[0,0,0,0] row_mask:0xf bank_mask:0xf
  v_mov_b32_dpp v10, v62 quad_perm:[2,2,2,2] row_mask:0xf bank_mask:0xf
  s_nop 0
  v_add_f32_dpp v9, v61, v9 quad_perm:[1,1,1,1] row_mask:0xf bank_mask:0xf
  v_add_f32_dpp v10, v63, v10 quad_perm:[3,3,3,3] row_mask:0xf bank_mask:0xf
  v_add_f32 v8, v9, v10
  v_max_f32 v5, v5, v8
  ds_write_b32 v40, v8 offset:1032
  v_xor_b32 v17, 0x1b00, v16
  s_waitcnt vmcnt(9)
  buffer_load_dwordx4 v[124:127], v17, s[16:19], 0 offen nt
  v_mfma_f32_16x16x32_bf16 v[68:71], v[132:135], v[28:31], v[68:71]
  v_mov_b32_dpp v9, v64 quad_perm:[0,0,0,0] row_mask:0xf bank_mask:0xf
  v_mov_b32_dpp v10, v66 quad_perm:[2,2,2,2] row_mask:0xf bank_mask:0xf
  s_nop 0
  v_add_f32_dpp v9, v65, v9 quad_perm:[1,1,1,1] row_mask:0xf bank_mask:0xf
  v_add_f32_dpp v10, v67, v10 quad_perm:[3,3,3,3] row_mask:0xf bank_mask:0xf
  v_add_f32 v8, v9, v10
  v_max_f32 v5, v5, v8
  ds_write_b32 v40, v8 offset:1036
  v_xor_b32 v18, 0x900, v16
  s_waitcnt vmcnt(9)
  buffer_load_dwordx4 v[128:131], v18, s[16:19], 0 offen nt
  v_mfma_f32_16x16x32_bf16 v[72:75], v[136:139], v[28:31], v[72:75]
  v_mov_b32_dpp v9, v68 quad_perm:[0,0,0,0] row_mask:0xf bank_mask:0xf
  v_mov_b32_dpp v10, v70 quad_perm:[2,2,2,2] row_mask:0xf bank_mask:0xf
  s_nop 0
  v_add_f32_dpp v9, v69, v9 quad_perm:[1,1,1,1] row_mask:0xf bank_mask:0xf
  v_add_f32_dpp v10, v71, v10 quad_perm:[3,3,3,3] row_mask:0xf bank_mask:0xf
  v_add_f32 v8, v9, v10
  v_max_f32 v5, v5, v8
  ds_write_b32 v40, v8 offset:1280
  v_xor_b32 v17, 0x1d7b00, v16
  s_waitcnt vmcnt(9)
  buffer_load_dwordx4 v[132:135], v17, s[16:19], 0 offen nt
  ds_read_b32 v23, v22
  v_mfma_f32_16x16x32_bf16 v[76:79], v[140:143], v[28:31], v[76:79]
  v_mov_b32_dpp v9, v72 quad_perm:[0,0,0,0] row_mask:0xf bank_mask:0xf
  v_mov_b32_dpp v10, v74 quad_perm:[2,2,2,2] row_mask:0xf bank_mask:0xf
  s_nop 0
  v_add_f32_dpp v9, v73, v9 quad_perm:[1,1,1,1] row_mask:0xf bank_mask:0xf
  v_add_f32_dpp v10, v75, v10 quad_perm:[3,3,3,3] row_mask:0xf bank_mask:0xf
  v_add_f32 v8, v9, v10
  v_max_f32 v5, v5, v8
  ds_write_b32 v40, v8 offset:1284
  v_xor_b32 v18, 0x1d6900, v16
  s_waitcnt vmcnt(9)
  buffer_load_dwordx4 v[136:139], v18, s[16:19], 0 offen nt
  v_mfma_f32_16x16x32_bf16 v[80:83], v[144:147], v[28:31], v[80:83]
  v_mov_b32_dpp v9, v76 quad_perm:[0,0,0,0] row_mask:0xf bank_mask:0xf
  v_mov_b32_dpp v10, v78 quad_perm:[2,2,2,2] row_mask:0xf bank_mask:0xf
  s_nop 0
  v_add_f32_dpp v9, v77, v9 quad_perm:[1,1,1,1] row_mask:0xf bank_mask:0xf
  v_add_f32_dpp v10, v79, v10 quad_perm:[3,3,3,3] row_mask:0xf bank_mask:0xf
  v_add_f32 v8, v9, v10
  v_max_f32 v5, v5, v8
  ds_write_b32 v40, v8 offset:1288
  v_xor_b32 v17, 0x1d6100, v16
  s_waitcnt vmcnt(9)
  buffer_load_dwordx4 v[140:143], v17, s[16:19], 0 offen nt
  v_mfma_f32_16x16x32_bf16 v[52:55], v[84:87], v[24:27], 0
  v_mov_b32_dpp v9, v80 quad_perm:[0,0,0,0] row_mask:0xf bank_mask:0xf
  v_mov_b32_dpp v10, v82 quad_perm:[2,2,2,2] row_mask:0xf bank_mask:0xf
  s_nop 0
  v_add_f32_dpp v9, v81, v9 quad_perm:[1,1,1,1] row_mask:0xf bank_mask:0xf
  v_add_f32_dpp v10, v83, v10 quad_perm:[3,3,3,3] row_mask:0xf bank_mask:0xf
  v_add_f32 v8, v9, v10
  v_max_f32 v5, v5, v8
  ds_write_b32 v40, v8 offset:1292
  v_xor_b32 v18, 0x1d7300, v16
  s_waitcnt vmcnt(9)
  buffer_load_dwordx4 v[144:147], v18, s[16:19], 0 offen nt
  s_waitcnt lgkmcnt(0)
  v_readfirstlane_b32 s38, v23
  v_mfma_f32_16x16x32_bf16 v[56:59], v[88:91], v[24:27], 0
  s_sub_u32 s29, s29, 1
  s_cmp_lg_u32 s29, 0
  s_cbranch_scc1 L_k
  s_branch L_k_e
L_k_2:
  s_waitcnt vmcnt(10)
  buffer_load_dwordx4 v[84:87], v16, s[16:19], 0 offen nt
  v_mfma_f32_16x16x32_bf16 v[60:63], v[92:95], v[24:27], 0
  v_xor_b32 v18, 0x1200, v16
  s_waitcnt vmcnt(10)
  buffer_load_dwordx4 v[88:91], v18, s[16:19], 0 offen nt
  s_add_u32 s25, s25, s24
  v_mfma_f32_16x16x32_bf16 v[64:67], v[96:99], v[24:27], 0
  v_xor_b32 v17, 0x1a00, v16
  s_waitcnt vmcnt(10)
  buffer_load_dwordx4 v[92:95], v17, s[16:19], 0 offen nt
  s_bitcmp1_b32 s25, 0
  s_cselect_b32 s31, 0x8a00, 0
  v_mfma_f32_16x16x32_bf16 v[68:71], v[100:103], v[24:27], 0
  v_xor_b32 v18, 0x800, v16
  s_waitcnt vmcnt(10)
  buffer_load_dwordx4 v[96:99], v18, s[16:19], 0 offen nt
  s_bitcmp1_b32 s25, 1
  s_cselect_b32 s26, 0xc9a00, 0
  s_xor_b32 s31, s31, s26
  v_mfma_f32_16x16x32_bf16 v[72:75], v[104:107], v[24:27], 0
  v_xor_b32 v17, 0x1d7a00, v16
  s_waitcnt vmcnt(10)
  buffer_load_dwordx4 v[100:103], v17, s[16:19], 0 offen nt
  s_bitcmp1_b32 s25, 2
  s_cselect_b32 s26, 0xd4c00, 0
  s_xor_b32 s31, s31, s26
  v_mfma_f32_16x16x32_bf16 v[76:79], v[108:111], v[24:27], 0
  v_xor_b32 v18, 0x1d6800, v16
  s_waitcnt vmcnt(10)
  buffer_load_dwordx4 v[104:107], v18, s[16:19], 0 offen nt
  s_bitcmp1_b32 s25, 3
  s_cselect_b32 s26, 0x40000, 0
  s_xor_b32 s31, s31, s26
  v_mfma_f32_16x16x32_bf16 v[80:83], v[112:115], v[24:27], 0
  v_xor_b32 v17, 0x1d6000, v16
  s_waitcnt vmcnt(10)
  buffer_load_dwordx4 v[108:111], v17, s[16:19], 0 offen nt
  s_bitcmp1_b32 s25, 4
  s_cselect_b32 s26, 0x157400, 0
  s_xor_b32 s31, s31, s26
  v_mfma_f32_16x16x32_bf16 v[52:55], v[116:119], v[28:31], v[52:55]
  v_xor_b32 v18, 0x1d7200, v16
  s_waitcnt vmcnt(10)
  buffer_load_dwordx4 v[112:115], v18, s[16:19], 0 offen nt
  s_bitcmp1_b32 s25, 5
  s_cselect_b32 s26, 0x13ea00, 0
  s_xor_b32 s31, s31, s26
  v_mfma_f32_16x16x32_bf16 v[56:59], v[120:123], v[28:31], v[56:59]
  s_nop 4
  v_mov_b32_dpp v9, v52 quad_perm:[0,0,0,0] row_mask:0xf bank_mask:0xf
  v_mov_b32_dpp v10, v54 quad_perm:[2,2,2,2] row_mask:0xf bank_mask:0xf
  s_nop 0
  v_add_f32_dpp v9, v53, v9 quad_perm:[1,1,1,1] row_mask:0xf bank_mask:0xf
  v_add_f32_dpp v10, v55, v10 quad_perm:[3,3,3,3] row_mask:0xf bank_mask:0xf
  v_add_f32 v8, v9, v10
  v_max_f32 v5, v5, v8
  ds_write_b32 v40, v8 offset:1024
  v_xor_b32 v17, 0x100, v16
  s_waitcnt vmcnt(10)
  buffer_load_dwordx4 v[116:119], v17, s[16:19], 0 offen nt
  v_mfma_f32_16x16x32_bf16 v[60:63], v[124:127], v[28:31], v[60:63]
  v_mov_b32_dpp v9, v56 quad_perm:[0,0,0,0] row_mask:0xf bank_mask:0xf
  v_mov_b32_dpp v10, v58 quad_perm:[2,2,2,2] row_mask:0xf bank_mask:0xf
  s_nop 0
  v_add_f32_dpp v9, v57, v9 quad_perm:[1,1,1,1] row_mask:0xf bank_mask:0xf
  v_add_f32_dpp v10, v59, v10 quad_perm:[3,3,3,3] row_mask:0xf bank_mask:0xf
  v_add_f32 v8, v9, v10
  v_max_f32 v5, v5, v8
  ds_write_b32 v40, v8 offset:1028
  v_xor_b32 v18, 0x1300, v16
  s_waitcnt vmcnt(10)
  buffer_load_dwordx4 v[120:123], v18, s[16:19], 0 offen nt
  v_mfma_f32_16x16x32_bf16 v[64:67], v[128:131], v[28:31], v[64:67]
  v_mov_b32_dpp v9, v60 quad_perm:[0,0,0,0] row_mask:0xf bank_mask:0xf
  v_mov_b32_dpp v10, v62 quad_perm:[2,2,2,2] row_mask:0xf bank_mask:0xf
  s_nop 0
  v_add_f32_dpp v9, v61, v9 quad_perm:[1,1,1,1] row_mask:0xf bank_mask:0xf
  v_add_f32_dpp v10, v63, v10 quad_perm:[3,3,3,3] row_mask:0xf bank_mask:0xf
  v_add_f32 v8, v9, v10
  v_max_f32 v5, v5, v8
  ds_write_b32 v40, v8 offset:1032
  v_xor_b32 v17, 0x1b00, v16
  s_waitcnt vmcnt(10)
  buffer_load_dwordx4 v[124:127], v17, s[16:19], 0 offen nt
  v_mfma_f32_16x16x32_bf16 v[68:71], v[132:135], v[28:31], v[68:71]
  v_mov_b32_dpp v9, v64 quad_perm:[0,0,0,0] row_mask:0xf bank_mask:0xf
  v_mov_b32_dpp v10, v66 quad_perm:[2,2,2,2] row_mask:0xf bank_mask:0xf
  s_nop 0
  v_add_f32_dpp v9, v65, v9 quad_perm:[1,1,1,1] row_mask:0xf bank_mask:0xf
  v_add_f32_dpp v10, v67, v10 quad_perm:[3,3,3,3] row_mask:0xf bank_mask:0xf
  v_add_f32 v8, v9, v10
  v_max_f32 v5, v5, v8
  ds_write_b32 v40, v8 offset:1036
  v_xor_b32 v18, 0x900, v16
  s_waitcnt vmcnt(10)
  buffer_load_dwordx4 v[128:131], v18, s[16:19], 0 offen nt
  v_mfma_f32_16x16x32_bf16 v[72:75], v[136:139], v[28:31], v[72:75]
  v_mov_b32_dpp v9, v68 quad_perm:[0,0,0,0] row_mask:0xf bank_mask:0xf
  v_mov_b32_dpp v10, v70 quad_perm:[2,2,2,2] row_mask:0xf bank_mask:0xf
  s_nop 0
  v_add_f32_dpp v9, v69, v9 quad_perm:[1,1,1,1] row_mask:0xf bank_mask:0xf
  v_add_f32_dpp v10, v71, v10 quad_perm:[3,3,3,3] row_mask:0xf bank_mask:0xf
  v_add_f32 v8, v9, v10
  v_max_f32 v5, v5, v8
  ds_write_b32 v40, v8 offset:1280
  v_xor_b32 v17, 0x1d7b00, v16
  s_waitcnt vmcnt(10)
  buffer_load_dwordx4 v[132:135], v17, s[16:19], 0 offen nt
  ds_read_b32 v23, v22
  v_mfma_f32_16x16x32_bf16 v[76:79], v[140:143], v[28:31], v[76:79]
  v_mov_b32_dpp v9, v72 quad_perm:[0,0,0,0] row_mask:0xf bank_mask:0xf
  v_mov_b32_dpp v10, v74 quad_perm:[2,2,2,2] row_mask:0xf bank_mask:0xf
  s_nop 0
  v_add_f32_dpp v9, v73, v9 quad_perm:[1,1,1,1] row_mask:0xf bank_mask:0xf
  v_add_f32_dpp v10, v75, v10 quad_perm:[3,3,3,3] row_mask:0xf bank_mask:0xf
  v_add_f32 v8, v9, v10
  v_max_f32 v5, v5, v8
  ds_write_b32 v40, v8 offset:1284
  v_xor_b32 v18, 0x1d6900, v16
  s_waitcnt vmcnt(10)
  buffer_load_dwordx4 v[136:139], v18, s[16:19], 0 offen nt
  v_mfma_f32_16x16x32_bf16 v[80:83], v[144:147], v[28:31], v[80:83]
  v_mov_b32_dpp v9, v76 quad_perm:[0,0,0,0] row_mask:0xf bank_mask:0xf
  v_mov_b32_dpp v10, v78 quad_perm:[2,2,2,2] row_mask:0xf bank_mask:0xf
  s_nop 0
  v_add_f32_dpp v9, v77, v9 quad_perm:[1,1,1,1] row_mask:0xf bank_mask:0xf
  v_add_f32_dpp v10, v79, v10 quad_perm:[3,3,3,3] row_mask:0xf bank_mask:0xf
  v_add_f32 v8, v9, v10
  v_max_f32 v5, v5, v8
  ds_write_b32 v40, v8 offset:1288
  v_xor_b32 v17, 0x1d6100, v16
  s_waitcnt vmcnt(10)
  buffer_load_dwordx4 v[140:143], v17, s[16:19], 0 offen nt
  v_mfma_f32_16x16x32_bf16 v[52:55], v[84:87], v[24:27], 0
  v_mov_b32_dpp v9, v80 quad_perm:[0,0,0,0] row_mask:0xf bank_mask:0xf
  v_mov_b32_dpp v10, v82 quad_perm:[2,2,2,2] row_mask:0xf bank_mask:0xf
  s_nop 0
  v_add_f32_dpp v9, v81, v9 quad_perm:[1,1,1,1] row_mask:0xf bank_mask:0xf
  v_add_f32_dpp v10, v83, v10 quad_perm:[3,3,3,3] row_mask:0xf bank_mask:0xf
  v_add_f32 v8, v9, v10
  v_max_f32 v5, v5, v8
  ds_write_b32 v40, v8 offset:1292
  v_xor_b32 v18, 0x1d7300, v16
  s_waitcnt vmcnt(10)
  buffer_load_dwordx4 v[144:147], v18, s[16:19], 0 offen nt
  s_waitcnt lgkmcnt(0)
  v_readfirstlane_b32 s38, v23
  v_mfma_f32_16x16x32_bf16 v[56:59], v[88:91], v[24:27], 0
  s_sub_u32 s29, s29, 1
  s_cmp_lg_u32 s29, 0
  s_cbranch_scc1 L_k
  s_branch L_k_e
L_k_0:
  s_waitcnt vmcnt(8)
  buffer_load_dwordx4 v[84:87], v16, s[16:19], 0 offen nt
  v_mfma_f32_16x16x32_bf16 v[60:63], v[92:95], v[24:27], 0
  v_xor_b32 v18, 0x1200, v16
  s_waitcnt vmcnt(8)
  buffer_load_dwordx4 v[88:91], v18, s[16:19], 0 offen nt
  s_add_u32 s25, s25, s24
  v_mfma_f32_16x16x32_bf16 v[64:67], v[96:99], v[24:27], 0
  v_xor_b32 v17, 0x1a00, v16
  s_waitcnt vmcnt(8)
  buffer_load_dwordx4 v[92:95], v17, s[16:19], 0 offen nt
  s_bitcmp1_b32 s25, 0
  s_cselect_b32 s31, 0x8a00, 0
  v_mfma_f32_16x16x32_bf16 v[68:71], v[100:103], v[24:27], 0
  v_xor_b32 v18, 0x800, v16
  s_waitcnt vmcnt(8)
  buffer_load_dwordx4 v[96:99], v18, s[16:19], 0 offen nt
  s_bitcmp1_b32 s25, 1
  s_cselect_b32 s26, 0xc9a00, 0
  s_xor_b32 s31, s31, s26
  v_mfma_f32_16x16x32_bf16 v[72:75], v[104:107], v[24:27], 0
  v_xor_b32 v17, 0x1d7a00, v16
  s_waitcnt vmcnt(8)
  buffer_load_dwordx4 v[100:103], v17, s[16:19], 0 offen nt
  s_bitcmp1_b32 s25, 2
  s_cselect_b32 s26, 0xd4c00, 0
  s_xor_b32 s31, s31, s26
  v_mfma_f32_16x16x32_bf16 v[76:79], v[108:111], v[24:27], 0
  v_xor_b32 v18, 0x1d6800, v16
  s_waitcnt vmcnt(8)
  buffer_load_dwordx4 v[104:107], v18, s[16:19], 0 offen nt
  s_bitcmp1_b32 s25, 3
  s_cselect_b32 s26, 0x40000, 0
  s_xor_b32 s31, s31, s26
  v_mfma_f32_16x16x32_bf16 v[80:83], v[112:115], v[24:27], 0
  v_xor_b32 v17, 0x1d6000, v16
  s_waitcnt vmcnt(8)
  buffer_load_dwordx4 v[108:111], v17, s[16:19], 0 offen nt
  s_bitcmp1_b32 s25, 4
  s_cselect_b32 s26, 0x157400, 0
  s_xor_b32 s31, s31, s26
  v_mfma_f32_16x16x32_bf16 v[52:55], v[116:119], v[28:31], v[52:55]
  v_xor_b32 v18, 0x1d7200, v16
  s_waitcnt vmcnt(8)
  buffer_load_dwordx4 v[112:115], v18, s[16:19], 0 offen nt
  s_bitcmp1_b32 s25, 5
  s_cselect_b32 s26, 0x13ea00, 0
  s_xor_b32 s31, s31, s26
  v_mfma_f32_16x16x32_bf16 v[56:59], v[120:123], v[28:31], v[56:59]
  s_nop 4
  v_mov_b32_dpp v9, v52 quad_perm:[0,0,0,0] row_mask:0xf bank_mask:0xf
  v_mov_b32_dpp v10, v54 quad_perm:[2,2,2,2] row_mask:0xf bank_mask:0xf
  s_nop 0
  v_add_f32_dpp v9, v53, v9 quad_perm:[1,1,1,1] row_mask:0xf bank_mask:0xf
  v_add_f32_dpp v10, v55, v10 quad_perm:[3,3,3,3] row_mask:0xf bank_mask:0xf
  v_add_f32 v8, v9, v10
  v_max_f32 v5, v5, v8
  ds_write_b32 v40, v8 offset:1024
  v_xor_b32 v17, 0x100, v16
  s_waitcnt vmcnt(8)
  buffer_load_dwordx4 v[116:119], v17, s[16:19], 0 offen nt
  v_mfma_f32_16x16x32_bf16 v[60:63], v[124:127], v[28:31], v[60:63]
  v_mov_b32_dpp v9, v56 quad_perm:[0,0,0,0] row_mask:0xf bank_mask:0xf
  v_mov_b32_dpp v10, v58 quad_perm:[2,2,2,2] row_mask:0xf bank_mask:0xf
  s_nop 0
  v_add_f32_dpp v9, v57, v9 quad_perm:[1,1,1,1] row_mask:0xf bank_mask:0xf
  v_add_f32_dpp v10, v59, v10 quad_perm:[3,3,3,3] row_mask:0xf bank_mask:0xf
  v_add_f32 v8, v9, v10
  v_max_f32 v5, v5, v8
  ds_write_b32 v40, v8 offset:1028
  v_xor_b32 v18, 0x1300, v16
  s_waitcnt vmcnt(8)
  buffer_load_dwordx4 v[120:123], v18, s[16:19], 0 offen nt
  v_mfma_f32_16x16x32_bf16 v[64:67], v[128:131], v[28:31], v[64:67]
  v_mov_b32_dpp v9, v60 quad_perm:[0,0,0,0] row_mask:0xf bank_mask:0xf
  v_mov_b32_dpp v10, v62 quad_perm:[2,2,2,2] row_mask:0xf bank_mask:0xf
  s_nop 0
  v_add_f32_dpp v9, v61, v9 quad_perm:[1,1,1,1] row_mask:0xf bank_mask:0xf
  v_add_f32_dpp v10, v63, v10 quad_perm:[3,3,3,3] row_mask:0xf bank_mask:0xf
  v_add_f32 v8, v9, v10
  v_max_f32 v5, v5, v8
  ds_write_b32 v40, v8 offset:1032
  v_xor_b32 v17, 0x1b00, v16
  s_waitcnt vmcnt(8)
  buffer_load_dwordx4 v[124:127], v17, s[16:19], 0 offen nt
  v_mfma_f32_16x16x32_bf16 v[68:71], v[132:135], v[28:31], v[68:71]
  v_mov_b32_dpp v9, v64 quad_perm:[0,0,0,0] row_mask:0xf bank_mask:0xf
  v_mov_b32_dpp v10, v66 quad_perm:[2,2,2,2] row_mask:0xf bank_mask:0xf
  s_nop 0
  v_add_f32_dpp v9, v65, v9 quad_perm:[1,1,1,1] row_mask:0xf bank_mask:0xf
  v_add_f32_dpp v10, v67, v10 quad_perm:[3,3,3,3] row_mask:0xf bank_mask:0xf
  v_add_f32 v8, v9, v10
  v_max_f32 v5, v5, v8
  ds_write_b32 v40, v8 offset:1036
  v_xor_b32 v18, 0x900, v16
  s_waitcnt vmcnt(8)
  buffer_load_dwordx4 v[128:131], v18, s[16:19], 0 offen nt
  v_mfma_f32_16x16x32_bf16 v[72:75], v[136:139], v[28:31], v[72:75]
  v_mov_b32_dpp v9, v68 quad_perm:[0,0,0,0] row_mask:0xf bank_mask:0xf
  v_mov_b32_dpp v10, v70 quad_perm:[2,2,2,2] row_mask:0xf bank_mask:0xf
  s_nop 0
  v_add_f32_dpp v9, v69, v9 quad_perm:[1,1,1,1] row_mask:0xf bank_mask:0xf
  v_add_f32_dpp v10, v71, v10 quad_perm:[3,3,3,3] row_mask:0xf bank_mask:0xf
  v_add_f32 v8, v9, v10
  v_max_f32 v5, v5, v8
  ds_write_b32 v40, v8 offset:1280
  v_xor_b32 v17, 0x1d7b00, v16
  s_waitcnt vmcnt(8)
  buffer_load_dwordx4 v[132:135], v17, s[16:19], 0 offen nt
  ds_read_b32 v23, v22
  v_mfma_f32_16x16x32_bf16 v[76:79], v[140:143], v[28:31], v[76:79]
  v_mov_b32_dpp v9, v72 quad_perm:[0,0,0,0] row_mask:0xf bank_mask:0xf
  v_mov_b32_dpp v10, v74 quad_perm:[2,2,2,2] row_mask:0xf bank_mask:0xf
  s_nop 0
  v_add_f32_dpp v9, v73, v9 quad_perm:[1,1,1,1] row_mask:0xf bank_mask:0xf
  v_add_f32_dpp v10, v75, v10 quad_perm:[3,3,3,3] row_mask:0xf bank_mask:0xf
  v_add_f32 v8, v9, v10
  v_max_f32 v5, v5, v8
  ds_write_b32 v40, v8 offset:1284
  v_xor_b32 v18, 0x1d6900, v16
  s_waitcnt vmcnt(8)
  buffer_load_dwordx4 v[136:139], v18, s[16:19], 0 offen nt
  v_mfma_f32_16x16x32_bf16 v[80:83], v[144:147], v[28:31], v[80:83]
  v_mov_b32_dpp v9, v76 quad_perm:[0,0,0,0] row_mask:0xf bank_mask:0xf
  v_mov_b32_dpp v10, v78 quad_perm:[2,2,2,2] row_mask:0xf bank_mask:0xf
  s_nop 0
  v_add_f32_dpp v9, v77, v9 quad_perm:[1,1,1,1] row_mask:0xf bank_mask:0xf
  v_add_f32_dpp v10, v79, v10 quad_perm:[3,3,3,3] row_mask:0xf bank_mask:0xf
  v_add_f32 v8, v9, v10
  v_max_f32 v5, v5, v8
  ds_write_b32 v40, v8 offset:1288
  v_xor_b32 v17, 0x1d6100, v16
  s_waitcnt vmcnt(8)
  buffer_load_dwordx4 v[140:143], v17, s[16:19], 0 offen nt
  v_mfma_f32_16x16x32_bf16 v[52:55], v[84:87], v[24:27], 0
  v_mov_b32_dpp v9, v80 quad_perm:[0,0,0,0] row_mask:0xf bank_mask:0xf
  v_mov_b32_dpp v10, v82 quad_perm:[2,2,2,2] row_mask:0xf bank_mask:0xf
  s_nop 0
  v_add_f32_dpp v9, v81, v9 quad_perm:[1,1,1,1] row_mask:0xf bank_mask:0xf
  v_add_f32_dpp v10, v83, v10 quad_perm:[3,3,3,3] row_mask:0xf bank_mask:0xf
  v_add_f32 v8, v9, v10
  v_max_f32 v5, v5, v8
  ds_write_b32 v40, v8 offset:1292
  v_xor_b32 v18, 0x1d7300, v16
  s_waitcnt vmcnt(8)
  buffer_load_dwordx4 v[144:147], v18, s[16:19], 0 offen nt
  s_waitcnt lgkmcnt(0)
  v_readfirstlane_b32 s38, v23
  v_mfma_f32_16x16x32_bf16 v[56:59], v[88:91], v[24:27], 0
  s_sub_u32 s29, s29, 1
  s_cmp_lg_u32 s29, 0
  s_cbranch_scc1 L_k
L_k_e:
  v_add_u32 v40, 1024, v40
  v_xor_b32 v16, s31, v2
  s_barrier
  s_waitcnt vmcnt(9)
  buffer_load_dwordx4 v[84:87], v16, s[20:23], 0 offen nt
  v_mfma_f32_16x16x32_bf16 v[60:63], v[92:95], v[24:27], 0
  v_xor_b32 v18, 0x1200, v16
  s_waitcnt vmcnt(9)
  buffer_load_dwordx4 v[88:91], v18, s[20:23], 0 offen nt
  s_add_u32 s25, s25, s24
  v_mfma_f32_16x16x32_bf16 v[64:67], v[96:99], v[24:27], 0
  v_xor_b32 v17, 0x1a00, v16
  s_waitcnt vmcnt(9)
  buffer_load_dwordx4 v[92:95], v17, s[20:23], 0 offen nt
  s_bitcmp1_b32 s25, 0
  s_cselect_b32 s31, 0x8a00, 0
  v_mfma_f32_16x16x32_bf16 v[68:71], v[100:103], v[24:27], 0
  v_xor_b32 v18, 0x800, v16
  s_waitcnt vmcnt(9)
  buffer_load_dwordx4 v[96:99], v18, s[20:23], 0 offen nt
  s_bitcmp1_b32 s25, 1
  s_cselect_b32 s26, 0xc9a00, 0
  s_xor_b32 s31, s31, s26
  v_mfma_f32_16x16x32_bf16 v[72:75], v[104:107], v[24:27], 0
  v_xor_b32 v17, 0x1d7a00, v16
  s_waitcnt vmcnt(9)
  buffer_load_dwordx4 v[100:103], v17, s[20:23], 0 offen nt
  s_bitcmp1_b32 s25, 2
  s_cselect_b32 s26, 0xd4c00, 0
  s_xor_b32 s31, s31, s26
  v_mfma_f32_16x16x32_bf16 v[76:79], v[108:111], v[24:27], 0
  v_xor_b32 v18, 0x1d6800, v16
  s_waitcnt vmcnt(9)
  buffer_load_dwordx4 v[104:107], v18, s[20:23], 0 offen nt
  s_bitcmp1_b32 s25, 3
  s_cselect_b32 s26, 0x40000, 0
  s_xor_b32 s31, s31, s26
  v_mfma_f32_16x16x32_bf16 v[80:83], v[112:115], v[24:27], 0
  v_xor_b32 v17, 0x1d6000, v16
  s_waitcnt vmcnt(9)
  buffer_load_dwordx4 v[108:111], v17, s[20:23], 0 offen nt
  s_bitcmp1_b32 s25, 4
  s_cselect_b32 s26, 0x157400, 0
  s_xor_b32 s31, s31, s26
  v_mfma_f32_16x16x32_bf16 v[52:55], v[116:119], v[28:31], v[52:55]
  v_xor_b32 v18, 0x1d7200, v16
  s_waitcnt vmcnt(9)
  buffer_load_dwordx4 v[112:115], v18, s[20:23], 0 offen nt
  s_bitcmp1_b32 s25, 5
  s_cselect_b32 s26, 0x13ea00, 0
  s_xor_b32 s31, s31, s26
  v_mfma_f32_16x16x32_bf16 v[56:59], v[120:123], v[28:31], v[56:59]
  s_nop 4
  v_mov_b32_dpp v9, v52 quad_perm:[0,0,0,0] row_mask:0xf bank_mask:0xf
  v_mov_b32_dpp v10, v54 quad_perm:[2,2,2,2] row_mask:0xf bank_mask:0xf
  s_nop 0
  v_add_f32_dpp v9, v53, v9 quad_perm:[1,1,1,1] row_mask:0xf bank_mask:0xf
  v_add_f32_dpp v10, v55, v10 quad_perm:[3,3,3,3] row_mask:0xf bank_mask:0xf
  v_add_f32 v8, v9, v10
  v_max_f32 v5, v5, v8
  ds_write_b32 v40, v8 offset:1024
  v_xor_b32 v17, 0x3000, v16
  s_waitcnt vmcnt(9)
  buffer_load_dwordx4 v[116:119], v17, s[20:23], 0 offen nt
  v_mfma_f32_16x16x32_bf16 v[60:63], v[124:127], v[28:31], v[60:63]
  v_mov_b32_dpp v9, v56 quad_perm:[0,0,0,0] row_mask:0xf bank_mask:0xf
  v_mov_b32_dpp v10, v58 quad_perm:[2,2,2,2] row_mask:0xf bank_mask:0xf
  s_nop 0
  v_add_f32_dpp v9, v57, v9 quad_perm:[1,1,1,1] row_mask:0xf bank_mask:0xf
  v_add_f32_dpp v10, v59, v10 quad_perm:[3,3,3,3] row_mask:0xf bank_mask:0xf
  v_add_f32 v8, v9, v10
  v_max_f32 v5, v5, v8
  ds_write_b32 v40, v8 offset:1028
  v_xor_b32 v18, 0x2200, v16
  s_waitcnt vmcnt(9)
  buffer_load_dwordx4 v[120:123], v18, s[20:23], 0 offen nt
  v_mfma_f32_16x16x32_bf16 v[64:67], v[128:131], v[28:31], v[64:67]
  v_mov_b32_dpp v9, v60 quad_perm:[0,0,0,0] row_mask:0xf bank_mask:0xf
  v_mov_b32_dpp v10, v62 quad_perm:[2,2,2,2] row_mask:0xf bank_mask:0xf
  s_nop 0
  v_add_f32_dpp v9, v61, v9 quad_perm:[1,1,1,1] row_mask:0xf bank_mask:0xf
  v_add_f32_dpp v10, v63, v10 quad_perm:[3,3,3,3] row_mask:0xf bank_mask:0xf
  v_add_f32 v8, v9, v10
  v_max_f32 v5, v5, v8
  ds_write_b32 v40, v8 offset:1032
  v_xor_b32 v17, 0x2a00, v16
  s_waitcnt vmcnt(9)
  buffer_load_dwordx4 v[124:127], v17, s[20:23], 0 offen nt
  v_mfma_f32_16x16x32_bf16 v[68:71], v[132:135], v[28:31], v[68:71]
  v_mov_b32_dpp v9, v64 quad_perm:[0,0,0,0] row_mask:0xf bank_mask:0xf
  v_mov_b32_dpp v10, v66 quad_perm:[2,2,2,2] row_mask:0xf bank_mask:0xf
  s_nop 0
  v_add_f32_dpp v9, v65, v9 quad_perm:[1,1,1,1] row_mask:0xf bank_mask:0xf
  v_add_f32_dpp v10, v67, v10 quad_perm:[3,3,3,3] row_mask:0xf bank_mask:0xf
  v_add_f32 v8, v9, v10
  v_max_f32 v5, v5, v8
  ds_write_b32 v40, v8 offset:1036
  v_xor_b32 v18, 0x3800, v16
  s_waitcnt vmcnt(9)
  buffer_load_dwordx4 v[128:131], v18, s[20:23], 0 offen nt
  v_mfma_f32_16x16x32_bf16 v[72:75], v[136:139], v[28:31], v[72:75]
  v_mov_b32_dpp v9, v68 quad_perm:[0,0,0,0] row_mask:0xf bank_mask:0xf
  v_mov_b32_dpp v10, v70 quad_perm:[2,2,2,2] row_mask:0xf bank_mask:0xf
  s_nop 0
  v_add_f32_dpp v9, v69, v9 quad_perm:[1,1,1,1] row_mask:0xf bank_mask:0xf
  v_add_f32_dpp v10, v71, v10 quad_perm:[3,3,3,3] row_mask:0xf bank_mask:0xf
  v_add_f32 v8, v9, v10
  v_max_f32 v5, v5, v8
  ds_write_b32 v40, v8 offset:1280
  v_xor_b32 v17, 0x1d4a00, v16
  s_waitcnt vmcnt(9)
  buffer_load_dwordx4 v[132:135], v17, s[20:23], 0 offen nt
  ds_read_b32 v23, v22
  v_mfma_f32_16x16x32_bf16 v[76:79], v[140:143], v[28:31], v[76:79]
  v_mov_b32_dpp v9, v72 quad_perm:[0,0,0,0] row_mask:0xf bank_mask:0xf
  v_mov_b32_dpp v10, v74 quad_perm:[2,2,2,2] row_mask:0xf bank_mask:0xf
  s_nop 0
  v_add_f32_dpp v9, v73, v9 quad_perm:[1,1,1,1] row_mask:0xf bank_mask:0xf
  v_add_f32_dpp v10, v75, v10 quad_perm:[3,3,3,3] row_mask:0xf bank_mask:0xf
  v_add_f32 v8, v9, v10
  v_max_f32 v5, v5, v8
  ds_write_b32 v40, v8 offset:1284
  v_xor_b32 v18, 0x1d5800, v16
  s_waitcnt vmcnt(9)
  buffer_load_dwordx4 v[136:139], v18, s[20:23], 0 offen nt
  v_mfma_f32_16x16x32_bf16 v[80:83], v[144:147], v[28:31], v[80:83]
  v_mov_b32_dpp v9, v76 quad_perm:[0,0,0,0] row_mask:0xf bank_mask:0xf
  v_mov_b32_dpp v10, v78 quad_perm:[2,2,2,2] row_mask:0xf bank_mask:0xf
  s_nop 0
  v_add_f32_dpp v9, v77, v9 quad_perm:[1,1,1,1] row_mask:0xf bank_mask:0xf
  v_add_f32_dpp v10, v79, v10 quad_perm:[3,3,3,3] row_mask:0xf bank_mask:0xf
  v_add_f32 v8, v9, v10
  v_max_f32 v5, v5, v8
  ds_write_b32 v40, v8 offset:1288
  s_nop 0
  v_mov_b32_dpp v9, v80 quad_perm:[0,0,0,0] row_mask:0xf bank_mask:0xf
  v_mov_b32_dpp v10, v82 quad_perm:[2,2,2,2] row_mask:0xf bank_mask:0xf
  s_nop 0
  v_add_f32_dpp v9, v81, v9 quad_perm:[1,1,1,1] row_mask:0xf bank_mask:0xf
  v_add_f32_dpp v10, v83, v10 quad_perm:[3,3,3,3] row_mask:0xf bank_mask:0xf
  v_add_f32 v8, v9, v10
  v_max_f32 v5, v5, v8
  ds_write_b32 v40, v8 offset:1292
  v_mov_b32 v9, v5
  s_lshl_b32 s26, s3, 8
  s_add_u32 s26, s26, 69120
  v_permlane32_swap_b32 v9, v5
  v_max_f32 v5, v5, v9
  v_mov_b32 v9, v5
  v_lshl_add_u32 v10, v0, 2, s26
  v_xor_b32 v8, 0x100, v10
  v_permlane16_swap_b32 v9, v5
  v_max_f32 v5, v5, v9
  ds_write_b32 v10, v5
  s_waitcnt lgkmcnt(0)
  s_barrier
  ds_read_b32 v9, v8
  ds_read_b32 v42, v41 offset:1536
  s_waitcnt lgkmcnt(1)
  v_max_f32 v5, v5, v9
  v_mul_f32 v6, s36, v5
  v_sub_f32 v6, 0, v6
  v_and_b32 v6, -2, v6
  v_add_f32 v7, v7, v11
  s_waitcnt lgkmcnt(0)
  v_fma_f32 v11, v42, s36, v6
  v_exp_f32 v11, v11
  s_nop 0
  v_cvt_pk_bf16_f32 v43, v11, v11
  ds_read_b32 v42, v41 offset:1792
  s_nop 0
  v_and_b32_dpp v12, v43, v3 quad_perm:[0,0,0,0] row_mask:0xf bank_mask:0xf
  v_and_b32_dpp v13, v43, v4 quad_perm:[0,0,0,0] row_mask:0xf bank_mask:0xf
  v_xor_b32 v17, 0x1d5000, v16
  s_waitcnt vmcnt(9)
  buffer_load_dwordx4 v[140:143], v17, s[20:23], 0 offen nt
  v_mfma_f32_16x16x16_bf16 v[32:35], v[12:13], v[84:85], v[32:35]
  v_mfma_f32_16x16x16_bf16 v[36:39], v[12:13], v[86:87], v[36:39]
  v_and_b32_dpp v14, v43, v3 quad_perm:[1,1,1,1] row_mask:0xf bank_mask:0xf
  v_and_b32_dpp v15, v43, v4 quad_perm:[1,1,1,1] row_mask:0xf bank_mask:0xf
  v_xor_b32 v18, 0x1d4200, v16
  s_waitcnt vmcnt(9)
  buffer_load_dwordx4 v[144:147], v18, s[20:23], 0 offen nt
  s_waitcnt lgkmcnt(0)
  v_readfirstlane_b32 s38, v23
  v_mfma_f32_16x16x16_bf16 v[32:35], v[14:15], v[88:89], v[32:35]
  v_mfma_f32_16x16x16_bf16 v[36:39], v[14:15], v[90:91], v[36:39]
  v_and_b32_dpp v12, v43, v3 quad_perm:[2,2,2,2] row_mask:0xf bank_mask:0xf
  v_and_b32_dpp v13, v43, v4 quad_perm:[2,2,2,2] row_mask:0xf bank_mask:0xf
  v_add_f32 v7, v7, v11
  s_waitcnt lgkmcnt(0)
  v_fma_f32 v11, v42, s36, v6
  v_exp_f32 v11, v11
  s_nop 0
  v_cvt_pk_bf16_f32 v44, v11, v11
  ds_read_b32 v42, v19 offset:2048
  s_mov_b32 s29, 59
  s_mov_b32 s33, 0
L_v:
  v_mov_b32 v20, v19
  v_add_u32 v41, s47, v41
  v_add_u32 v19, s47, v19
L_v_go:
  v_xor_b32 v16, s31, v2
  s_barrier
  s_bitcmp1_b32 s38, 0
  s_cbranch_scc1 L_v_c
  s_and_b32 s37, s37, 0xffffff
  s_add_u32 s37, s37, s38
  s_lshr_b32 s26, s37, 24
  s_cmp_eq_u32 s26, 2
  s_cbranch_scc1 L_v_2
  s_cmp_eq_u32 s26, 0
  s_cbranch_scc1 L_v_0
L_v_1:
  s_waitcnt vmcnt(9)
  buffer_load_dwordx4 v[84:87], v16, s[20:23], 0 offen nt
  v_mfma_f32_16x16x16_bf16 v[32:35], v[12:13], v[92:93], v[32:35]
  v_mfma_f32_16x16x16_bf16 v[36:39], v[12:13], v[94:95], v[36:39]
  v_and_b32_dpp v14, v43, v3 quad_perm:[3,3,3,3] row_mask:0xf bank_mask:0xf
  v_and_b32_dpp v15, v43, v4 quad_perm:[3,3,3,3] row_mask:0xf bank_mask:0xf
  v_xor_b32 v18, 0x1200, v16
  s_waitcnt vmcnt(9)
  buffer_load_dwordx4 v[88:91], v18, s[20:23], 0 offen nt
  s_add_u32 s25, s25, s24
  v_mfma_f32_16x16x16_bf16 v[32:35], v[14:15], v[96:97], v[32:35]
  v_mfma_f32_16x16x16_bf16 v[36:39], v[14:15], v[98:99], v[36:39]
  v_and_b32_dpp v12, v44, v3 quad_perm:[0,0,0,0] row_mask:0xf bank_mask:0xf
  v_and_b32_dpp v13, v44, v4 quad_perm:[0,0,0,0] row_mask:0xf bank_mask:0xf
  v_xor_b32 v17, 0x1a00, v16
  s_waitcnt vmcnt(9)
  buffer_load_dwordx4 v[92:95], v17, s[20:23], 0 offen nt
  s_bitcmp1_b32 s25, 0
  s_cselect_b32 s31, 0x8a00, 0
  v_mfma_f32_16x16x16_bf16 v[32:35], v[12:13], v[100:101], v[32:35]
  v_mfma_f32_16x16x16_bf16 v[36:39], v[12:13], v[102:103], v[36:39]
  v_and_b32_dpp v14, v44, v3 quad_perm:[1,1,1,1] row_mask:0xf bank_mask:0xf
  v_and_b32_dpp v15, v44, v4 quad_perm:[1,1,1,1] row_mask:0xf bank_mask:0xf
  v_xor_b32 v18, 0x800, v16
  s_waitcnt vmcnt(9)
  buffer_load_dwordx4 v[96:99], v18, s[20:23], 0 offen nt
  s_bitcmp1_b32 s25, 1
  s_cselect_b32 s26, 0xc9a00, 0
  s_xor_b32 s31, s31, s26
  v_mfma_f32_16x16x16_bf16 v[32:35], v[14:15], v[104:105], v[32:35]
  v_mfma_f32_16x16x16_bf16 v[36:39], v[14:15], v[106:107], v[36:39]
  v_and_b32_dpp v12, v44, v3 quad_perm:[2,2,2,2] row_mask:0xf bank_mask:0xf
  v_and_b32_dpp v13, v44, v4 quad_perm:[2,2,2,2] row_mask:0xf bank_mask:0xf
  v_add_f32 v7, v7, v11
  s_waitcnt lgkmcnt(0)
  v_fma_f32 v11, v42, s36, v6
  v_exp_f32 v11, v11
  s_nop 0
  v_cvt_pk_bf16_f32 v43, v11, v11
  ds_read_b32 v42, v20 offset:2304
  v_xor_b32 v17, 0x1d7a00, v16
  s_waitcnt vmcnt(9)
  buffer_load_dwordx4 v[100:103], v17, s[20:23], 0 offen nt
  s_bitcmp1_b32 s25, 2
  s_cselect_b32 s26, 0xd4c00, 0
  s_xor_b32 s31, s31, s26
  v_mfma_f32_16x16x16_bf16 v[32:35], v[12:13], v[108:109], v[32:35]
  v_mfma_f32_16x16x16_bf16 v[36:39], v[12:13], v[110:111], v[36:39]
  v_and_b32_dpp v14, v44, v3 quad_perm:[3,3,3,3] row_mask:0xf bank_mask:0xf
  v_and_b32_dpp v15, v44, v4 quad_perm:[3,3,3,3] row_mask:0xf bank_mask:0xf
  v_xor_b32 v18, 0x1d6800, v16
  s_waitcnt vmcnt(9)
  buffer_load_dwordx4 v[104:107], v18, s[20:23], 0 offen nt
  s_bitcmp1_b32 s25, 3
  s_cselect_b32 s26, 0x40000, 0
  s_xor_b32 s31, s31, s26
  v_mfma_f32_16x16x16_bf16 v[32:35], v[14:15], v[112:113], v[32:35]
  v_mfma_f32_16x16x16_bf16 v[36:39], v[14:15], v[114:115], v[36:39]
  v_and_b32_dpp v12, v43, v3 quad_perm:[0,0,0,0] row_mask:0xf bank_mask:0xf
  v_and_b32_dpp v13, v43, v4 quad_perm:[0,0,0,0] row_mask:0xf bank_mask:0xf
  v_xor_b32 v17, 0x1d6000, v16
  s_waitcnt vmcnt(9)
  buffer_load_dwordx4 v[108:111], v17, s[20:23], 0 offen nt
  s_bitcmp1_b32 s25, 4
  s_cselect_b32 s26, 0x157400, 0
  s_xor_b32 s31, s31, s26
  v_mfma_f32_16x16x16_bf16 v[32:35], v[12:13], v[116:117], v[32:35]
  v_mfma_f32_16x16x16_bf16 v[36:39], v[12:13], v[118:119], v[36:39]
  v_and_b32_dpp v14, v43, v3 quad_perm:[1,1,1,1] row_mask:0xf bank_mask:0xf
  v_and_b32_dpp v15, v43, v4 quad_perm:[1,1,1,1] row_mask:0xf bank_mask:0xf
  v_xor_b32 v18, 0x1d7200, v16
  s_waitcnt vmcnt(9)
  buffer_load_dwordx4 v[112:115], v18, s[20:23], 0 offen nt
  s_bitcmp1_b32 s25, 5
  s_cselect_b32 s26, 0x13ea00, 0
  s_xor_b32 s31, s31, s26
  v_mfma_f32_16x16x16_bf16 v[32:35], v[14:15], v[120:121], v[32:35]
  v_mfma_f32_16x16x16_bf16 v[36:39], v[14:15], v[122:123], v[36:39]
  v_and_b32_dpp v12, v43, v3 quad_perm:[2,2,2,2] row_mask:0xf bank_mask:0xf
  v_and_b32_dpp v13, v43, v4 quad_perm:[2,2,2,2] row_mask:0xf bank_mask:0xf
  v_add_f32 v7, v7, v11
  s_waitcnt lgkmcnt(0)
  v_fma_f32 v11, v42, s36, v6
  v_exp_f32 v11, v11
  s_nop 0
  v_cvt_pk_bf16_f32 v44, v11, v11
  ds_read_b32 v42, v41 offset:1536
  v_xor_b32 v17, 0x3000, v16
  s_waitcnt vmcnt(9)
  buffer_load_dwordx4 v[116:119], v17, s[20:23], 0 offen nt
  v_mfma_f32_16x16x16_bf16 v[32:35], v[12:13], v[124:125], v[32:35]
  v_mfma_f32_16x16x16_bf16 v[36:39], v[12:13], v[126:127], v[36:39]
  v_and_b32_dpp v14, v43, v3 quad_perm:[3,3,3,3] row_mask:0xf bank_mask:0xf
  v_and_b32_dpp v15, v43, v4 quad_perm:[3,3,3,3] row_mask:0xf bank_mask:0xf
  v_xor_b32 v18, 0x2200, v16
  s_waitcnt vmcnt(9)
  buffer_load_dwordx4 v[120:123], v18, s[20:23], 0 offen nt
  v_mfma_f32_16x16x16_bf16 v[32:35], v[14:15], v[128:129], v[32:35]
  v_mfma_f32_16x16x16_bf16 v[36:39], v[14:15], v[130:131], v[36:39]
  v_and_b32_dpp v12, v44, v3 quad_perm:[0,0,0,0] row_mask:0xf bank_mask:0xf
  v_and_b32_dpp v13, v44, v4 quad_perm:[0,0,0,0] row_mask:0xf bank_mask:0xf
  v_xor_b32 v17, 0x2a00, v16
  s_waitcnt vmcnt(9)
  buffer_load_dwordx4 v[124:127], v17, s[20:23], 0 offen nt
  v_mfma_f32_16x16x16_bf16 v[32:35], v[12:13], v[132:133], v[32:35]
  v_mfma_f32_16x16x16_bf16 v[36:39], v[12:13], v[134:135], v[36:39]
  v_and_b32_dpp v14, v44, v3 quad_perm:[1,1,1,1] row_mask:0xf bank_mask:0xf
  v_and_b32_dpp v15, v44, v4 quad_perm:[1,1,1,1] row_mask:0xf bank_mask:0xf
  v_xor_b32 v18, 0x3800, v16
  s_waitcnt vmcnt(9)
  buffer_load_dwordx4 v[128:131], v18, s[20:23], 0 offen nt
  v_mfma_f32_16x16x16_bf16 v[32:35], v[14:15], v[136:137], v[32:35]
  v_mfma_f32_16x16x16_bf16 v[36:39], v[14:15], v[138:139], v[36:39]
  v_and_b32_dpp v12, v44, v3 quad_perm:[2,2,2,2] row_mask:0xf bank_mask:0xf
  v_and_b32_dpp v13, v44, v4 quad_perm:[2,2,2,2] row_mask:0xf bank_mask:0xf
  v_add_f32 v7, v7, v11
  s_waitcnt lgkmcnt(0)
  v_fma_f32 v11, v42, s36, v6
  v_exp_f32 v11, v11
  s_nop 0
  v_cvt_pk_bf16_f32 v43, v11, v11
  ds_read_b32 v42, v41 offset:1792
  v_xor_b32 v17, 0x1d4a00, v16
  s_waitcnt vmcnt(9)
  buffer_load_dwordx4 v[132:135], v17, s[20:23], 0 offen nt
  ds_read_b32 v23, v22
  v_mfma_f32_16x16x16_bf16 v[32:35], v[12:13], v[140:141], v[32:35]
  v_mfma_f32_16x16x16_bf16 v[36:39], v[12:13], v[142:143], v[36:39]
  v_and_b32_dpp v14, v44, v3 quad_perm:[3,3,3,3] row_mask:0xf bank_mask:0xf
  v_and_b32_dpp v15, v44, v4 quad_perm:[3,3,3,3] row_mask:0xf bank_mask:0xf
  v_xor_b32 v18, 0x1d5800, v16
  s_waitcnt vmcnt(9)
  buffer_load_dwordx4 v[136:139], v18, s[20:23], 0 offen nt
  v_mfma_f32_16x16x16_bf16 v[32:35], v[14:15], v[144:145], v[32:35]
  v_mfma_f32_16x16x16_bf16 v[36:39], v[14:15], v[146:147], v[36:39]
  v_and_b32_dpp v12, v43, v3 quad_perm:[0,0,0,0] row_mask:0xf bank_mask:0xf
  v_and_b32_dpp v13, v43, v4 quad_perm:[0,0,0,0] row_mask:0xf bank_mask:0xf
  v_xor_b32 v17, 0x1d5000, v16
  s_waitcnt vmcnt(9)
  buffer_load_dwordx4 v[140:143], v17, s[20:23], 0 offen nt
  s_cmp_lg_u32 s39, 0
  s_cbranch_scc1 L_glue1
L_back1:
  v_mfma_f32_16x16x16_bf16 v[32:35], v[12:13], v[84:85], v[32:35]
  v_mfma_f32_16x16x16_bf16 v[36:39], v[12:13], v[86:87], v[36:39]
  v_and_b32_dpp v14, v43, v3 quad_perm:[1,1,1,1] row_mask:0xf bank_mask:0xf
  v_and_b32_dpp v15, v43, v4 quad_perm:[1,1,1,1] row_mask:0xf bank_mask:0xf
  v_xor_b32 v18, 0x1d4200, v16
  s_waitcnt vmcnt(9)
  buffer_load_dwordx4 v[144:147], v18, s[20:23], 0 offen nt
  s_waitcnt lgkmcnt(0)
  v_readfirstlane_b32 s38, v23
  v_mfma_f32_16x16x16_bf16 v[32:35], v[14:15], v[88:89], v[32:35]
  v_mfma_f32_16x16x16_bf16 v[36:39], v[14:15], v[90:91], v[36:39]
  v_and_b32_dpp v12, v43, v3 quad_perm:[2,2,2,2] row_mask:0xf bank_mask:0xf
  v_and_b32_dpp v13, v43, v4 quad_perm:[2,2,2,2] row_mask:0xf bank_mask:0xf
  v_add_f32 v7, v7, v11
  s_waitcnt lgkmcnt(0)
  v_fma_f32 v11, v42, s36, v6
  v_exp_f32 v11, v11
  s_nop 0
  v_cvt_pk_bf16_f32 v44, v11, v11
  ds_read_b32 v42, v19 offset:2048
  s_sub_u32 s29, s29, 1
  s_cmp_lg_u32 s29, 0
  s_cbranch_scc1 L_v
  s_branch L_v_e
L_pad_v0:
  s_branch L_hpadd
L_v_2:
  s_waitcnt vmcnt(10)
  buffer_load_dwordx4 v[84:87], v16, s[20:23], 0 offen nt
  v_mfma_f32_16x16x16_bf16 v[32:35], v[12:13], v[92:93], v[32:35]
  v_mfma_f32_16x16x16_bf16 v[36:39], v[12:13], v[94:95], v[36:39]
  v_and_b32_dpp v14, v43, v3 quad_perm:[3,3,3,3] row_mask:0xf bank_mask:0xf
  v_and_b32_dpp v15, v43, v4 quad_perm:[3,3,3,3] row_mask:0xf bank_mask:0xf
  v_xor_b32 v18, 0x1200, v16
  s_waitcnt vmcnt(10)
  buffer_load_dwordx4 v[88:91], v18, s[20:23], 0 offen nt
  s_add_u32 s25, s25, s24
  v_mfma_f32_16x16x16_bf16 v[32:35], v[14:15], v[96:97], v[32:35]
  v_mfma_f32_16x16x16_bf16 v[36:39], v[14:15], v[98:99], v[36:39]
  v_and_b32_dpp v12, v44, v3 quad_perm:[0,0,0,0] row_mask:0xf bank_mask:0xf
  v_and_b32_dpp v13, v44, v4 quad_perm:[0,0,0,0] row_mask:0xf bank_mask:0xf
  v_xor_b32 v17, 0x1a00, v16
  s_waitcnt vmcnt(10)
  buffer_load_dwordx4 v[92:95], v17, s[20:23], 0 offen nt
  s_bitcmp1_b32 s25, 0
  s_cselect_b32 s31, 0x8a00, 0
  v_mfma_f32_16x16x16_bf16 v[32:35], v[12:13], v[100:101], v[32:35]
  v_mfma_f32_16x16x16_bf16 v[36:39], v[12:13], v[102:103], v[36:39]
  v_and_b32_dpp v14, v44, v3 quad_perm:[1,1,1,1] row_mask:0xf bank_mask:0xf
  v_and_b32_dpp v15, v44, v4 quad_perm:[1,1,1,1] row_mask:0xf bank_mask:0xf
  v_xor_b32 v18, 0x800, v16
  s_waitcnt vmcnt(10)
  buffer_load_dwordx4 v[96:99], v18, s[20:23], 0 offen nt
  s_bitcmp1_b32 s25, 1
  s_cselect_b32 s26, 0xc9a00, 0
  s_xor_b32 s31, s31, s26
  v_mfma_f32_16x16x16_bf16 v[32:35], v[14:15], v[104:105], v[32:35]
  v_mfma_f32_16x16x16_bf16 v[36:39], v[14:15], v[106:107], v[36:39]
  v_and_b32_dpp v12, v44, v3 quad_perm:[2,2,2,2] row_mask:0xf bank_mask:0xf
  v_and_b32_dpp v13, v44, v4 quad_perm:[2,2,2,2] row_mask:0xf bank_mask:0xf
  v_add_f32 v7, v7, v11
  s_waitcnt lgkmcnt(0)
  v_fma_f32 v11, v42, s36, v6
  v_exp_f32 v11, v11
  s_nop 0
  v_cvt_pk_bf16_f32 v43, v11, v11
  ds_read_b32 v42, v20 offset:2304
  v_xor_b32 v17, 0x1d7a00, v16
  s_waitcnt vmcnt(10)
  buffer_load_dwordx4 v[100:103], v17, s[20:23], 0 offen nt
  s_bitcmp1_b32 s25, 2
  s_cselect_b32 s26, 0xd4c00, 0
  s_xor_b32 s31, s31, s26
  v_mfma_f32_16x16x16_bf16 v[32:35], v[12:13], v[108:109], v[32:35]
  v_mfma_f32_16x16x16_bf16 v[36:39], v[12:13], v[110:111], v[36:39]
  v_and_b32_dpp v14, v44, v3 quad_perm:[3,3,3,3] row_mask:0xf bank_mask:0xf
  v_and_b32_dpp v15, v44, v4 quad_perm:[3,3,3,3] row_mask:0xf bank_mask:0xf
  v_xor_b32 v18, 0x1d6800, v16
  s_waitcnt vmcnt(10)
  buffer_load_dwordx4 v[104:107], v18, s[20:23], 0 offen nt
  s_bitcmp1_b32 s25, 3
  s_cselect_b32 s26, 0x40000, 0
  s_xor_b32 s31, s31, s26
  v_mfma_f32_16x16x16_bf16 v[32:35], v[14:15], v[112:113], v[32:35]
  v_mfma_f32_16x16x16_bf16 v[36:39], v[14:15], v[114:115], v[36:39]
  v_and_b32_dpp v12, v43, v3 quad_perm:[0,0,0,0] row_mask:0xf bank_mask:0xf
  v_and_b32_dpp v13, v43, v4 quad_perm:[0,0,0,0] row_mask:0xf bank_mask:0xf
  v_xor_b32 v17, 0x1d6000, v16
  s_waitcnt vmcnt(10)
  buffer_load_dwordx4 v[108:111], v17, s[20:23], 0 offen nt
  s_bitcmp1_b32 s25, 4
  s_cselect_b32 s26, 0x157400, 0
  s_xor_b32 s31, s31, s26
  v_mfma_f32_16x16x16_bf16 v[32:35], v[12:13], v[116:117], v[32:35]
  v_mfma_f32_16x16x16_bf16 v[36:39], v[12:13], v[118:119], v[36:39]
  v_and_b32_dpp v14, v43, v3 quad_perm:[1,1,1,1] row_mask:0xf bank_mask:0xf
  v_and_b32_dpp v15, v43, v4 quad_perm:[1,1,1,1] row_mask:0xf bank_mask:0xf
  v_xor_b32 v18, 0x1d7200, v16
  s_waitcnt vmcnt(10)
  buffer_load_dwordx4 v[112:115], v18, s[20:23], 0 offen nt
  s_bitcmp1_b32 s25, 5
  s_cselect_b32 s26, 0x13ea00, 0
  s_xor_b32 s31, s31, s26
  v_mfma_f32_16x16x16_bf16 v[32:35], v[14:15], v[120:121], v[32:35]
  v_mfma_f32_16x16x16_bf16 v[36:39], v[14:15], v[122:123], v[36:39]
  v_and_b32_dpp v12, v43, v3 quad_perm:[2,2,2,2] row_mask:0xf bank_mask:0xf
  v_and_b32_dpp v13, v43, v4 quad_perm:[2,2,2,2] row_mask:0xf bank_mask:0xf
  v_add_f32 v7, v7, v11
  s_waitcnt lgkmcnt(0)
  v_fma_f32 v11, v42, s36, v6
  v_exp_f32 v11, v11
  s_nop 0
  v_cvt_pk_bf16_f32 v44, v11, v11
  ds_read_b32 v42, v41 offset:1536
  v_xor_b32 v17, 0x3000, v16
  s_waitcnt vmcnt(10)
  buffer_load_dwordx4 v[116:119], v17, s[20:23], 0 offen nt
  v_mfma_f32_16x16x16_bf16 v[32:35], v[12:13], v[124:125], v[32:35]
  v_mfma_f32_16x16x16_bf16 v[36:39], v[12:13], v[126:127], v[36:39]
  v_and_b32_dpp v14, v43, v3 quad_perm:[3,3,3,3] row_mask:0xf bank_mask:0xf
  v_and_b32_dpp v15, v43, v4 quad_perm:[3,3,3,3] row_mask:0xf bank_mask:0xf
  v_xor_b32 v18, 0x2200, v16
  s_waitcnt vmcnt(10)
  buffer_load_dwordx4 v[120:123], v18, s[20:23], 0 offen nt
  v_mfma_f32_16x16x16_bf16 v[32:35], v[14:15], v[128:129], v[32:35]
  v_mfma_f32_16x16x16_bf16 v[36:39], v[14:15], v[130:131], v[36:39]
  v_and_b32_dpp v12, v44, v3 quad_perm:[0,0,0,0] row_mask:0xf bank_mask:0xf
  v_and_b32_dpp v13, v44, v4 quad_perm:[0,0,0,0] row_mask:0xf bank_mask:0xf
  v_xor_b32 v17, 0x2a00, v16
  s_waitcnt vmcnt(10)
  buffer_load_dwordx4 v[124:127], v17, s[20:23], 0 offen nt
  v_mfma_f32_16x16x16_bf16 v[32:35], v[12:13], v[132:133], v[32:35]
  v_mfma_f32_16x16x16_bf16 v[36:39], v[12:13], v[134:135], v[36:39]
  v_and_b32_dpp v14, v44, v3 quad_perm:[1,1,1,1] row_mask:0xf bank_mask:0xf
  v_and_b32_dpp v15, v44, v4 quad_perm:[1,1,1,1] row_mask:0xf bank_mask:0xf
  v_xor_b32 v18, 0x3800, v16
  s_waitcnt vmcnt(10)
  buffer_load_dwordx4 v[128:131], v18, s[20:23], 0 offen nt
  v_mfma_f32_16x16x16_bf16 v[32:35], v[14:15], v[136:137], v[32:35]
  v_mfma_f32_16x16x16_bf16 v[36:39], v[14:15], v[138:139], v[36:39]
  v_and_b32_dpp v12, v44, v3 quad_perm:[2,2,2,2] row_mask:0xf bank_mask:0xf
  v_and_b32_dpp v13, v44, v4 quad_perm:[2,2,2,2] row_mask:0xf bank_mask:0xf
  v_add_f32 v7, v7, v11
  s_waitcnt lgkmcnt(0)
  v_fma_f32 v11, v42, s36, v6
  v_exp_f32 v11, v11
  s_nop 0
  v_cvt_pk_bf16_f32 v43, v11, v11
  ds_read_b32 v42, v41 offset:1792
  v_xor_b32 v17, 0x1d4a00, v16
  s_waitcnt vmcnt(10)
  buffer_load_dwordx4 v[132:135], v17, s[20:23], 0 offen nt
  ds_read_b32 v23, v22
  v_mfma_f32_16x16x16_bf16 v[32:35], v[12:13], v[140:141], v[32:35]
  v_mfma_f32_16x16x16_bf16 v[36:39], v[12:13], v[142:143], v[36:39]
  v_and_b32_dpp v14, v44, v3 quad_perm:[3,3,3,3] row_mask:0xf bank_mask:0xf
  v_and_b32_dpp v15, v44, v4 quad_perm:[3,3,3,3] row_mask:0xf bank_mask:0xf
  v_xor_b32 v18, 0x1d5800, v16
  s_waitcnt vmcnt(10)
  buffer_load_dwordx4 v[136:139], v18, s[20:23], 0 offen nt
  v_mfma_f32_16x16x16_bf16 v[32:35], v[14:15], v[144:145], v[32:35]
  v_mfma_f32_16x16x16_bf16 v[36:39], v[14:15], v[146:147], v[36:39]
  v_and_b32_dpp v12, v43, v3 quad_perm:[0,0,0,0] row_mask:0xf bank_mask:0xf
  v_and_b32_dpp v13, v43, v4 quad_perm:[0,0,0,0] row_mask:0xf bank_mask:0xf
  v_xor_b32 v17, 0x1d5000, v16
  s_waitcnt vmcnt(10)
  buffer_load_dwordx4 v[140:143], v17, s[20:23], 0 offen nt
  s_cmp_lg_u32 s39, 0
  s_cbranch_scc1 L_glue2
L_back2:
  v_mfma_f32_16x16x16_bf16 v[32:35], v[12:13], v[84:85], v[32:35]
  v_mfma_f32_16x16x16_bf16 v[36:39], v[12:13], v[86:87], v[36:39]
  v_and_b32_dpp v14, v43, v3 quad_perm:[1,1,1,1] row_mask:0xf bank_mask:0xf
  v_and_b32_dpp v15, v43, v4 quad_perm:[1,1,1,1] row_mask:0xf bank_mask:0xf
  v_xor_b32 v18, 0x1d4200, v16
  s_waitcnt vmcnt(10)
  buffer_load_dwordx4 v[144:147], v18, s[20:23], 0 offen nt
  s_waitcnt lgkmcnt(0)
  v_readfirstlane_b32 s38, v23
  v_mfma_f32_16x16x16_bf16 v[32:35], v[14:15], v[88:89], v[32:35]
  v_mfma_f32_16x16x16_bf16 v[36:39], v[14:15], v[90:91], v[36:39]
  v_and_b32_dpp v12, v43, v3 quad_perm:[2,2,2,2] row_mask:0xf bank_mask:0xf
  v_and_b32_dpp v13, v43, v4 quad_perm:[2,2,2,2] row_mask:0xf bank_mask:0xf
  v_add_f32 v7, v7, v11
  s_waitcnt lgkmcnt(0)
  v_fma_f32 v11, v42, s36, v6
  v_exp_f32 v11, v11
  s_nop 0
  v_cvt_pk_bf16_f32 v44, v11, v11
  ds_read_b32 v42, v19 offset:2048
  s_sub_u32 s29, s29, 1
  s_cmp_lg_u32 s29, 0
  s_cbranch_scc1 L_v
  s_branch L_v_e
L_v_0:
  s_waitcnt vmcnt(8)
  buffer_load_dwordx4 v[84:87], v16, s[20:23], 0 offen nt
  v_mfma_f32_16x16x16_bf16 v[32:35], v[12:13], v[92:93], v[32:35]
  v_mfma_f32_16x16x16_bf16 v[36:39], v[12:13], v[94:95], v[36:39]
  v_and_b32_dpp v14, v43, v3 quad_perm:[3,3,3,3] row_mask:0xf bank_mask:0xf
  v_and_b32_dpp v15, v43, v4 quad_perm:[3,3,3,3] row_mask:0xf bank_mask:0xf
  v_xor_b32 v18, 0x1200, v16
  s_waitcnt vmcnt(8)
  buffer_load_dwordx4 v[88:91], v18, s[20:23], 0 offen nt
  s_add_u32 s25, s25, s24
  v_mfma_f32_16x16x16_bf16 v[32:35], v[14:15], v[96:97], v[32:35]
  v_mfma_f32_16x16x16_bf16 v[36:39], v[14:15], v[98:99], v[36:39]
  v_and_b32_dpp v12, v44, v3 quad_perm:[0,0,0,0] row_mask:0xf bank_mask:0xf
  v_and_b32_dpp v13, v44, v4 quad_perm:[0,0,0,0] row_mask:0xf bank_mask:0xf
  v_xor_b32 v17, 0x1a00, v16
  s_waitcnt vmcnt(8)
  buffer_load_dwordx4 v[92:95], v17, s[20:23], 0 offen nt
  s_bitcmp1_b32 s25, 0
  s_cselect_b32 s31, 0x8a00, 0
  v_mfma_f32_16x16x16_bf16 v[32:35], v[12:13], v[100:101], v[32:35]
  v_mfma_f32_16x16x16_bf16 v[36:39], v[12:13], v[102:103], v[36:39]
  v_and_b32_dpp v14, v44, v3 quad_perm:[1,1,1,1] row_mask:0xf bank_mask:0xf
  v_and_b32_dpp v15, v44, v4 quad_perm:[1,1,1,1] row_mask:0xf bank_mask:0xf
  v_xor_b32 v18, 0x800, v16
  s_waitcnt vmcnt(8)
  buffer_load_dwordx4 v[96:99], v18, s[20:23], 0 offen nt
  s_bitcmp1_b32 s25, 1
  s_cselect_b32 s26, 0xc9a00, 0
  s_xor_b32 s31, s31, s26
  v_mfma_f32_16x16x16_bf16 v[32:35], v[14:15], v[104:105], v[32:35]
  v_mfma_f32_16x16x16_bf16 v[36:39], v[14:15], v[106:107], v[36:39]
  v_and_b32_dpp v12, v44, v3 quad_perm:[2,2,2,2] row_mask:0xf bank_mask:0xf
  v_and_b32_dpp v13, v44, v4 quad_perm:[2,2,2,2] row_mask:0xf bank_mask:0xf
  v_add_f32 v7, v7, v11
  s_waitcnt lgkmcnt(0)
  v_fma_f32 v11, v42, s36, v6
  v_exp_f32 v11, v11
  s_nop 0
  v_cvt_pk_bf16_f32 v43, v11, v11
  ds_read_b32 v42, v20 offset:2304
  v_xor_b32 v17, 0x1d7a00, v16
  s_waitcnt vmcnt(8)
  buffer_load_dwordx4 v[100:103], v17, s[20:23], 0 offen nt
  s_bitcmp1_b32 s25, 2
  s_cselect_b32 s26, 0xd4c00, 0
  s_xor_b32 s31, s31, s26
  v_mfma_f32_16x16x16_bf16 v[32:35], v[12:13], v[108:109], v[32:35]
  v_mfma_f32_16x16x16_bf16 v[36:39], v[12:13], v[110:111], v[36:39]
  v_and_b32_dpp v14, v44, v3 quad_perm:[3,3,3,3] row_mask:0xf bank_mask:0xf
  v_and_b32_dpp v15, v44, v4 quad_perm:[3,3,3,3] row_mask:0xf bank_mask:0xf
  v_xor_b32 v18, 0x1d6800, v16
  s_waitcnt vmcnt(8)
  buffer_load_dwordx4 v[104:107], v18, s[20:23], 0 offen nt
  s_bitcmp1_b32 s25, 3
  s_cselect_b32 s26, 0x40000, 0
  s_xor_b32 s31, s31, s26
  v_mfma_f32_16x16x16_bf16 v[32:35], v[14:15], v[112:113], v[32:35]
  v_mfma_f32_16x16x16_bf16 v[36:39], v[14:15], v[114:115], v[36:39]
  v_and_b32_dpp v12, v43, v3 quad_perm:[0,0,0,0] row_mask:0xf bank_mask:0xf
  v_and_b32_dpp v13, v43, v4 quad_perm:[0,0,0,0] row_mask:0xf bank_mask:0xf
  v_xor_b32 v17, 0x1d6000, v16
  s_waitcnt vmcnt(8)
  buffer_load_dwordx4 v[108:111], v17, s[20:23], 0 offen nt
  s_bitcmp1_b32 s25, 4
  s_cselect_b32 s26, 0x157400, 0
  s_xor_b32 s31, s31, s26
  v_mfma_f32_16x16x16_bf16 v[32:35], v[12:13], v[116:117], v[32:35]
  v_mfma_f32_16x16x16_bf16 v[36:39], v[12:13], v[118:119], v[36:39]
  v_and_b32_dpp v14, v43, v3 quad_perm:[1,1,1,1] row_mask:0xf bank_mask:0xf
  v_and_b32_dpp v15, v43, v4 quad_perm:[1,1,1,1] row_mask:0xf bank_mask:0xf
  v_xor_b32 v18, 0x1d7200, v16
  s_waitcnt vmcnt(8)
  buffer_load_dwordx4 v[112:115], v18, s[20:23], 0 offen nt
  s_bitcmp1_b32 s25, 5
  s_cselect_b32 s26, 0x13ea00, 0
  s_xor_b32 s31, s31, s26
  v_mfma_f32_16x16x16_bf16 v[32:35], v[14:15], v[120:121], v[32:35]
  v_mfma_f32_16x16x16_bf16 v[36:39], v[14:15], v[122:123], v[36:39]
  v_and_b32_dpp v12, v43, v3 quad_perm:[2,2,2,2] row_mask:0xf bank_mask:0xf
  v_and_b32_dpp v13, v43, v4 quad_perm:[2,2,2,2] row_mask:0xf bank_mask:0xf
  v_add_f32 v7, v7, v11
  s_waitcnt lgkmcnt(0)
  v_fma_f32 v11, v42, s36, v6
  v_exp_f32 v11, v11
  s_nop 0
  v_cvt_pk_bf16_f32 v44, v11, v11
  ds_read_b32 v42, v41 offset:1536
  v_xor_b32 v17, 0x3000, v16
  s_waitcnt vmcnt(8)
  buffer_load_dwordx4 v[116:119], v17, s[20:23], 0 offen nt
  v_mfma_f32_16x16x16_bf16 v[32:35], v[12:13], v[124:125], v[32:35]
  v_mfma_f32_16x16x16_bf16 v[36:39], v[12:13], v[126:127], v[36:39]
  v_and_b32_dpp v14, v43, v3 quad_perm:[3,3,3,3] row_mask:0xf bank_mask:0xf
  v_and_b32_dpp v15, v43, v4 quad_perm:[3,3,3,3] row_mask:0xf bank_mask:0xf
  v_xor_b32 v18, 0x2200, v16
  s_waitcnt vmcnt(8)
  buffer_load_dwordx4 v[120:123], v18, s[20:23], 0 offen nt
  v_mfma_f32_16x16x16_bf16 v[32:35], v[14:15], v[128:129], v[32:35]
  v_mfma_f32_16x16x16_bf16 v[36:39], v[14:15], v[130:131], v[36:39]
  v_and_b32_dpp v12, v44, v3 quad_perm:[0,0,0,0] row_mask:0xf bank_mask:0xf
  v_and_b32_dpp v13, v44, v4 quad_perm:[0,0,0,0] row_mask:0xf bank_mask:0xf
  v_xor_b32 v17, 0x2a00, v16
  s_waitcnt vmcnt(8)
  buffer_load_dwordx4 v[124:127], v17, s[20:23], 0 offen nt
  v_mfma_f32_16x16x16_bf16 v[32:35], v[12:13], v[132:133], v[32:35]
  v_mfma_f32_16x16x16_bf16 v[36:39], v[12:13], v[134:135], v[36:39]
  v_and_b32_dpp v14, v44, v3 quad_perm:[1,1,1,1] row_mask:0xf bank_mask:0xf
  v_and_b32_dpp v15, v44, v4 quad_perm:[1,1,1,1] row_mask:0xf bank_mask:0xf
  v_xor_b32 v18, 0x3800, v16
  s_waitcnt vmcnt(8)
  buffer_load_dwordx4 v[128:131], v18, s[20:23], 0 offen nt
  v_mfma_f32_16x16x16_bf16 v[32:35], v[14:15], v[136:137], v[32:35]
  v_mfma_f32_16x16x16_bf16 v[36:39], v[14:15], v[138:139], v[36:39]
  v_and_b32_dpp v12, v44, v3 quad_perm:[2,2,2,2] row_mask:0xf bank_mask:0xf
  v_and_b32_dpp v13, v44, v4 quad_perm:[2,2,2,2] row_mask:0xf bank_mask:0xf
  v_add_f32 v7, v7, v11
  s_waitcnt lgkmcnt(0)
  v_fma_f32 v11, v42, s36, v6
  v_exp_f32 v11, v11
  s_nop 0
  v_cvt_pk_bf16_f32 v43, v11, v11
  ds_read_b32 v42, v41 offset:1792
  v_xor_b32 v17, 0x1d4a00, v16
  s_waitcnt vmcnt(8)
  buffer_load_dwordx4 v[132:135], v17, s[20:23], 0 offen nt
  ds_read_b32 v23, v22
  v_mfma_f32_16x16x16_bf16 v[32:35], v[12:13], v[140:141], v[32:35]
  v_mfma_f32_16x16x16_bf16 v[36:39], v[12:13], v[142:143], v[36:39]
  v_and_b32_dpp v14, v44, v3 quad_perm:[3,3,3,3] row_mask:0xf bank_mask:0xf
  v_and_b32_dpp v15, v44, v4 quad_perm:[3,3,3,3] row_mask:0xf bank_mask:0xf
  v_xor_b32 v18, 0x1d5800, v16
  s_waitcnt vmcnt(8)
  buffer_load_dwordx4 v[136:139], v18, s[20:23], 0 offen nt
  v_mfma_f32_16x16x16_bf16 v[32:35], v[14:15], v[144:145], v[32:35]
  v_mfma_f32_16x16x16_bf16 v[36:39], v[14:15], v[146:147], v[36:39]
  v_and_b32_dpp v12, v43, v3 quad_perm:[0,0,0,0] row_mask:0xf bank_mask:0xf
  v_and_b32_dpp v13, v43, v4 quad_perm:[0,0,0,0] row_mask:0xf bank_mask:0xf
  v_xor_b32 v17, 0x1d5000, v16
  s_waitcnt vmcnt(8)
  buffer_load_dwordx4 v[140:143], v17, s[20:23], 0 offen nt
  s_cmp_lg_u32 s39, 0
  s_cbranch_scc1 L_glue3
L_back3:
  v_mfma_f32_16x16x16_bf16 v[32:35], v[12:13], v[84:85], v[32:35]
  v_mfma_f32_16x16x16_bf16 v[36:39], v[12:13], v[86:87], v[36:39]
  v_and_b32_dpp v14, v43, v3 quad_perm:[1,1,1,1] row_mask:0xf bank_mask:0xf
  v_and_b32_dpp v15, v43, v4 quad_perm:[1,1,1,1] row_mask:0xf bank_mask:0xf
  v_xor_b32 v18, 0x1d4200, v16
  s_waitcnt vmcnt(8)
  buffer_load_dwordx4 v[144:147], v18, s[20:23], 0 offen nt
  s_waitcnt lgkmcnt(0)
  v_readfirstlane_b32 s38, v23
  v_mfma_f32_16x16x16_bf16 v[32:35], v[14:15], v[88:89], v[32:35]
  v_mfma_f32_16x16x16_bf16 v[36:39], v[14:15], v[90:91], v[36:39]
  v_and_b32_dpp v12, v43, v3 quad_perm:[2,2,2,2] row_mask:0xf bank_mask:0xf
  v_and_b32_dpp v13, v43, v4 quad_perm:[2,2,2,2] row_mask:0xf bank_mask:0xf
  v_add_f32 v7, v7, v11
  s_waitcnt lgkmcnt(0)
  v_fma_f32 v11, v42, s36, v6
  v_exp_f32 v11, v11
  s_nop 0
  v_cvt_pk_bf16_f32 v44, v11, v11
  ds_read_b32 v42, v19 offset:2048
  s_sub_u32 s29, s29, 1
  s_cmp_lg_u32 s29, 0
  s_cbranch_scc1 L_v
  s_branch L_v_e
L_v_c:
  s_waitcnt vmcnt(13)
  buffer_load_dwordx4 v[84:87], v16, s[20:23], 0 offen nt
  v_mfma_f32_16x16x16_bf16 v[32:35], v[12:13], v[92:93], v[32:35]
  v_mfma_f32_16x16x16_bf16 v[36:39], v[12:13], v[94:95], v[36:39]
  v_and_b32_dpp v14, v43, v3 quad_perm:[3,3,3,3] row_mask:0xf bank_mask:0xf
  v_and_b32_dpp v15, v43, v4 quad_perm:[3,3,3,3] row_mask:0xf bank_mask:0xf
  v_xor_b32 v18, 0x1200, v16
  s_waitcnt vmcnt(13)
  buffer_load_dwordx4 v[88:91], v18, s[20:23], 0 offen nt
  s_add_u32 s25, s25, s24
  v_mfma_f32_16x16x16_bf16 v[32:35], v[14:15], v[96:97], v[32:35]
  v_mfma_f32_16x16x16_bf16 v[36:39], v[14:15], v[98:99], v[36:39]
  v_and_b32_dpp v12, v44, v3 quad_perm:[0,0,0,0] row_mask:0xf bank_mask:0xf
  v_and_b32_dpp v13, v44, v4 quad_perm:[0,0,0,0] row_mask:0xf bank_mask:0xf
  v_xor_b32 v17, 0x1a00, v16
  s_waitcnt vmcnt(13)
  buffer_load_dwordx4 v[92:95], v17, s[20:23], 0 offen nt
  s_bitcmp1_b32 s25, 0
  s_cselect_b32 s31, 0x8a00, 0
  v_mfma_f32_16x16x16_bf16 v[32:35], v[12:13], v[100:101], v[32:35]
  v_mfma_f32_16x16x16_bf16 v[36:39], v[12:13], v[102:103], v[36:39]
  v_and_b32_dpp v14, v44, v3 quad_perm:[1,1,1,1] row_mask:0xf bank_mask:0xf
  v_and_b32_dpp v15, v44, v4 quad_perm:[1,1,1,1] row_mask:0xf bank_mask:0xf
  v_xor_b32 v18, 0x800, v16
  s_waitcnt vmcnt(13)
  buffer_load_dwordx4 v[96:99], v18, s[20:23], 0 offen nt
  s_bitcmp1_b32 s25, 1
  s_cselect_b32 s26, 0xc9a00, 0
  s_xor_b32 s31, s31, s26
  v_mfma_f32_16x16x16_bf16 v[32:35], v[14:15], v[104:105], v[32:35]
  v_mfma_f32_16x16x16_bf16 v[36:39], v[14:15], v[106:107], v[36:39]
  v_and_b32_dpp v12, v44, v3 quad_perm:[2,2,2,2] row_mask:0xf bank_mask:0xf
  v_and_b32_dpp v13, v44, v4 quad_perm:[2,2,2,2] row_mask:0xf bank_mask:0xf
  v_add_f32 v7, v7, v11
  s_waitcnt lgkmcnt(0)
  v_fma_f32 v11, v42, s36, v6
  v_exp_f32 v11, v11
  s_nop 0
  v_cvt_pk_bf16_f32 v43, v11, v11
  ds_read_b32 v42, v20 offset:2304
  v_xor_b32 v17, 0x1d7a00, v16
  s_waitcnt vmcnt(13)
  buffer_load_dwordx4 v[100:103], v17, s[20:23], 0 offen nt
  s_bitcmp1_b32 s25, 2
  s_cselect_b32 s26, 0xd4c00, 0
  s_xor_b32 s31, s31, s26
  v_mfma_f32_16x16x16_bf16 v[32:35], v[12:13], v[108:109], v[32:35]
  v_mfma_f32_16x16x16_bf16 v[36:39], v[12:13], v[110:111], v[36:39]
  v_and_b32_dpp v14, v44, v3 quad_perm:[3,3,3,3] row_mask:0xf bank_mask:0xf
  v_and_b32_dpp v15, v44, v4 quad_perm:[3,3,3,3] row_mask:0xf bank_mask:0xf
  v_xor_b32 v18, 0x1d6800, v16
  s_waitcnt vmcnt(13)
  buffer_load_dwordx4 v[104:107], v18, s[20:23], 0 offen nt
  s_bitcmp1_b32 s25, 3
  s_cselect_b32 s26, 0x40000, 0
  s_xor_b32 s31, s31, s26
  v_mfma_f32_16x16x16_bf16 v[32:35], v[14:15], v[112:113], v[32:35]
  v_mfma_f32_16x16x16_bf16 v[36:39], v[14:15], v[114:115], v[36:39]
  v_and_b32_dpp v12, v43, v3 quad_perm:[0,0,0,0] row_mask:0xf bank_mask:0xf
  v_and_b32_dpp v13, v43, v4 quad_perm:[0,0,0,0] row_mask:0xf bank_mask:0xf
  v_xor_b32 v17, 0x1d6000, v16
  s_waitcnt vmcnt(13)
  buffer_load_dwordx4 v[108:111], v17, s[20:23], 0 offen nt
  s_bitcmp1_b32 s25, 4
  s_cselect_b32 s26, 0x157400, 0
  s_xor_b32 s31, s31, s26
  v_mfma_f32_16x16x16_bf16 v[32:35], v[12:13], v[116:117], v[32:35]
  v_mfma_f32_16x16x16_bf16 v[36:39], v[12:13], v[118:119], v[36:39]
  v_and_b32_dpp v14, v43, v3 quad_perm:[1,1,1,1] row_mask:0xf bank_mask:0xf
  v_and_b32_dpp v15, v43, v4 quad_perm:[1,1,1,1] row_mask:0xf bank_mask:0xf
  v_xor_b32 v18, 0x1d7200, v16
  s_waitcnt vmcnt(13)
  buffer_load_dwordx4 v[112:115], v18, s[20:23], 0 offen nt
  s_bitcmp1_b32 s25, 5
  s_cselect_b32 s26, 0x13ea00, 0
  s_xor_b32 s31, s31, s26
  v_mfma_f32_16x16x16_bf16 v[32:35], v[14:15], v[120:121], v[32:35]
  v_mfma_f32_16x16x16_bf16 v[36:39], v[14:15], v[122:123], v[36:39]
  v_and_b32_dpp v12, v43, v3 quad_perm:[2,2,2,2] row_mask:0xf bank_mask:0xf
  v_and_b32_dpp v13, v43, v4 quad_perm:[2,2,2,2] row_mask:0xf bank_mask:0xf
  v_add_f32 v7, v7, v11
  s_waitcnt lgkmcnt(0)
  v_fma_f32 v11, v42, s36, v6
  v_exp_f32 v11, v11
  s_nop 0
  v_cvt_pk_bf16_f32 v44, v11, v11
  ds_read_b32 v42, v41 offset:1536
  v_xor_b32 v17, 0x3000, v16
  s_waitcnt vmcnt(13)
  buffer_load_dwordx4 v[116:119], v17, s[20:23], 0 offen nt
  v_mfma_f32_16x16x16_bf16 v[32:35], v[12:13], v[124:125], v[32:35]
  v_mfma_f32_16x16x16_bf16 v[36:39], v[12:13], v[126:127], v[36:39]
  v_and_b32_dpp v14, v43, v3 quad_perm:[3,3,3,3] row_mask:0xf bank_mask:0xf
  v_and_b32_dpp v15, v43, v4 quad_perm:[3,3,3,3] row_mask:0xf bank_mask:0xf
  v_xor_b32 v18, 0x2200, v16
  s_waitcnt vmcnt(13)
  buffer_load_dwordx4 v[120:123], v18, s[20:23], 0 offen nt
  v_mfma_f32_16x16x16_bf16 v[32:35], v[14:15], v[128:129], v[32:35]
  v_mfma_f32_16x16x16_bf16 v[36:39], v[14:15], v[130:131], v[36:39]
  v_and_b32_dpp v12, v44, v3 quad_perm:[0,0,0,0] row_mask:0xf bank_mask:0xf
  v_and_b32_dpp v13, v44, v4 quad_perm:[0,0,0,0] row_mask:0xf bank_mask:0xf
  v_xor_b32 v17, 0x2a00, v16
  s_waitcnt vmcnt(13)
  buffer_load_dwordx4 v[124:127], v17, s[20:23], 0 offen nt
  v_mfma_f32_16x16x16_bf16 v[32:35], v[12:13], v[132:133], v[32:35]
  v_mfma_f32_16x16x16_bf16 v[36:39], v[12:13], v[134:135], v[36:39]
  v_and_b32_dpp v14, v44, v3 quad_perm:[1,1,1,1] row_mask:0xf bank_mask:0xf
  v_and_b32_dpp v15, v44, v4 quad_perm:[1,1,1,1] row_mask:0xf bank_mask:0xf
  v_xor_b32 v18, 0x3800, v16
  s_waitcnt vmcnt(13)
  buffer_load_dwordx4 v[128:131], v18, s[20:23], 0 offen nt
  v_mfma_f32_16x16x16_bf16 v[32:35], v[14:15], v[136:137], v[32:35]
  v_mfma_f32_16x16x16_bf16 v[36:39], v[14:15], v[138:139], v[36:39]
  v_and_b32_dpp v12, v44, v3 quad_perm:[2,2,2,2] row_mask:0xf bank_mask:0xf
  v_and_b32_dpp v13, v44, v4 quad_perm:[2,2,2,2] row_mask:0xf bank_mask:0xf
  v_add_f32 v7, v7, v11
  s_waitcnt lgkmcnt(0)
  v_fma_f32 v11, v42, s36, v6
  v_exp_f32 v11, v11
  s_nop 0
  v_cvt_pk_bf16_f32 v43, v11, v11
  ds_read_b32 v42, v41 offset:1792
  v_xor_b32 v17, 0x1d4a00, v16
  s_waitcnt vmcnt(13)
  buffer_load_dwordx4 v[132:135], v17, s[20:23], 0 offen nt
  ds_read_b32 v23, v22
  v_mfma_f32_16x16x16_bf16 v[32:35], v[12:13], v[140:141], v[32:35]
  v_mfma_f32_16x16x16_bf16 v[36:39], v[12:13], v[142:143], v[36:39]
  v_and_b32_dpp v14, v44, v3 quad_perm:[3,3,3,3] row_mask:0xf bank_mask:0xf
  v_and_b32_dpp v15, v44, v4 quad_perm:[3,3,3,3] row_mask:0xf bank_mask:0xf
  v_xor_b32 v18, 0x1d5800, v16
  s_waitcnt vmcnt(13)
  buffer_load_dwordx4 v[136:139], v18, s[20:23], 0 offen nt
  v_mfma_f32_16x16x16_bf16 v[32:35], v[14:15], v[144:145], v[32:35]
  v_mfma_f32_16x16x16_bf16 v[36:39], v[14:15], v[146:147], v[36:39]
  v_and_b32_dpp v12, v43, v3 quad_perm:[0,0,0,0] row_mask:0xf bank_mask:0xf
  v_and_b32_dpp v13, v43, v4 quad_perm:[0,0,0,0] row_mask:0xf bank_mask:0xf
  v_xor_b32 v17, 0x1d5000, v16
  s_waitcnt vmcnt(13)
  buffer_load_dwordx4 v[140:143], v17, s[20:23], 0 offen nt
  s_cmp_lg_u32 s39, 0
  s_cbranch_scc1 L_glue4
L_back4:
  v_mfma_f32_16x16x16_bf16 v[32:35], v[12:13], v[84:85], v[32:35]
  v_mfma_f32_16x16x16_bf16 v[36:39], v[12:13], v[86:87], v[36:39]
  v_and_b32_dpp v14, v43, v3 quad_perm:[1,1,1,1] row_mask:0xf bank_mask:0xf
  v_and_b32_dpp v15, v43, v4 quad_perm:[1,1,1,1] row_mask:0xf bank_mask:0xf
  v_xor_b32 v18, 0x1d4200, v16
  s_waitcnt vmcnt(13)
  buffer_load_dwordx4 v[144:147], v18, s[20:23], 0 offen nt
  s_waitcnt lgkmcnt(0)
  v_readfirstlane_b32 s38, v23
  v_mfma_f32_16x16x16_bf16 v[32:35], v[14:15], v[88:89], v[32:35]
  v_mfma_f32_16x16x16_bf16 v[36:39], v[14:15], v[90:91], v[36:39]
  v_and_b32_dpp v12, v43, v3 quad_perm:[2,2,2,2] row_mask:0xf bank_mask:0xf
  v_and_b32_dpp v13, v43, v4 quad_perm:[2,2,2,2] row_mask:0xf bank_mask:0xf
  v_add_f32 v7, v7, v11
  s_waitcnt lgkmcnt(0)
  v_fma_f32 v11, v42, s36, v6
  v_exp_f32 v11, v11
  s_nop 0
  v_cvt_pk_bf16_f32 v44, v11, v11
  ds_read_b32 v42, v19 offset:2048
  s_sub_u32 s29, s29, 1
  s_cmp_lg_u32 s29, 0
  s_cbranch_scc1 L_v
L_v_e:
  v_mov_b32 v20, v19
  s_add_u32 s33, s33, 1
  s_cmp_eq_u32 s33, 3
  s_cbranch_scc1 L_drain
  s_mov_b32 s39, s33
  s_mov_b32 s29, 2
  s_mov_b32 s24, 2
  s_mov_b32 s47, 2048
  s_add_u32 s25, s3, 60
  s_mov_b32 s31, s46
  s_cmp_eq_u32 s33, 2
  s_cselect_b32 s26, -1, s44
  s_and_b32 s26, s26, 0x100
  v_xor_b32 v2, s26, v2
  s_lshl_b32 s26, s3, 9
  s_lshl_b32 s32, s25, 10
  s_add_u32 s32, s32, 512
  v_lshl_add_u32 v41, v0, 2, s32
  v_subrev_u32 v19, s26, v41
  v_add_u32 v41, s26, v41
  s_branch L_v_go
L_drain:
  s_waitcnt vmcnt(13)
  s_nop 0
  v_mfma_f32_16x16x16_bf16 v[32:35], v[12:13], v[92:93], v[32:35]
  v_mfma_f32_16x16x16_bf16 v[36:39], v[12:13], v[94:95], v[36:39]
  v_and_b32_dpp v14, v43, v3 quad_perm:[3,3,3,3] row_mask:0xf bank_mask:0xf
  v_and_b32_dpp v15, v43, v4 quad_perm:[3,3,3,3] row_mask:0xf bank_mask:0xf
  s_waitcnt vmcnt(12)
  s_nop 0
  v_mfma_f32_16x16x16_bf16 v[32:35], v[14:15], v[96:97], v[32:35]
  v_mfma_f32_16x16x16_bf16 v[36:39], v[14:15], v[98:99], v[36:39]
  v_and_b32_dpp v12, v44, v3 quad_perm:[0,0,0,0] row_mask:0xf bank_mask:0xf
  v_and_b32_dpp v13, v44, v4 quad_perm:[0,0,0,0] row_mask:0xf bank_mask:0xf
  s_waitcnt vmcnt(11)
  s_nop 0
  v_mfma_f32_16x16x16_bf16 v[32:35], v[12:13], v[100:101], v[32:35]
  v_mfma_f32_16x16x16_bf16 v[36:39], v[12:13], v[102:103], v[36:39]
  v_and_b32_dpp v14, v44, v3 quad_perm:[1,1,1,1] row_mask:0xf bank_mask:0xf
  v_and_b32_dpp v15, v44, v4 quad_perm:[1,1,1,1] row_mask:0xf bank_mask:0xf
  s_waitcnt vmcnt(10)
  s_nop 0
  v_mfma_f32_16x16x16_bf16 v[32:35], v[14:15], v[104:105], v[32:35]
  v_mfma_f32_16x16x16_bf16 v[36:39], v[14:15], v[106:107], v[36:39]
  v_and_b32_dpp v12, v44, v3 quad_perm:[2,2,2,2] row_mask:0xf bank_mask:0xf
  v_and_b32_dpp v13, v44, v4 quad_perm:[2,2,2,2] row_mask:0xf bank_mask:0xf
  v_add_f32 v7, v7, v11
  s_waitcnt lgkmcnt(0)
  v_fma_f32 v11, v42, s36, v6
  v_exp_f32 v11, v11
  s_nop 0
  v_cvt_pk_bf16_f32 v43, v11, v11
  ds_read_b32 v42, v20 offset:2304
  s_waitcnt vmcnt(9)
  s_nop 0
  v_mfma_f32_16x16x16_bf16 v[32:35], v[12:13], v[108:109], v[32:35]
  v_mfma_f32_16x16x16_bf16 v[36:39], v[12:13], v[110:111], v[36:39]
  v_and_b32_dpp v14, v44, v3 quad_perm:[3,3,3,3] row_mask:0xf bank_mask:0xf
  v_and_b32_dpp v15, v44, v4 quad_perm:[3,3,3,3] row_mask:0xf bank_mask:0xf
  s_waitcnt vmcnt(8)
  s_nop 0
  v_mfma_f32_16x16x16_bf16 v[32:35], v[14:15], v[112:113], v[32:35]
  v_mfma_f32_16x16x16_bf16 v[36:39], v[14:15], v[114:115], v[36:39]
  v_and_b32_dpp v12, v43, v3 quad_perm:[0,0,0,0] row_mask:0xf bank_mask:0xf
  v_and_b32_dpp v13, v43, v4 quad_perm:[0,0,0,0] row_mask:0xf bank_mask:0xf
  s_waitcnt vmcnt(7)
  s_nop 0
  v_mfma_f32_16x16x16_bf16 v[32:35], v[12:13], v[116:117], v[32:35]
  v_mfma_f32_16x16x16_bf16 v[36:39], v[12:13], v[118:119], v[36:39]
  v_and_b32_dpp v14, v43, v3 quad_perm:[1,1,1,1] row_mask:0xf bank_mask:0xf
  v_and_b32_dpp v15, v43, v4 quad_perm:[1,1,1,1] row_mask:0xf bank_mask:0xf
  s_waitcnt vmcnt(6)
  s_nop 0
  v_mfma_f32_16x16x16_bf16 v[32:35], v[14:15], v[120:121], v[32:35]
  v_mfma_f32_16x16x16_bf16 v[36:39], v[14:15], v[122:123], v[36:39]
  v_and_b32_dpp v12, v43, v3 quad_perm:[2,2,2,2] row_mask:0xf bank_mask:0xf
  v_and_b32_dpp v13, v43, v4 quad_perm:[2,2,2,2] row_mask:0xf bank_mask:0xf
  v_add_f32 v7, v7, v11
  s_waitcnt lgkmcnt(0)
  v_fma_f32 v11, v42, s36, v6
  v_exp_f32 v11, v11
  s_nop 0
  v_cvt_pk_bf16_f32 v44, v11, v11
  s_waitcnt vmcnt(5)
  s_nop 0
  v_mfma_f32_16x16x16_bf16 v[32:35], v[12:13], v[124:125], v[32:35]
  v_mfma_f32_16x16x16_bf16 v[36:39], v[12:13], v[126:127], v[36:39]
  v_and_b32_dpp v14, v43, v3 quad_perm:[3,3,3,3] row_mask:0xf bank_mask:0xf
  v_and_b32_dpp v15, v43, v4 quad_perm:[3,3,3,3] row_mask:0xf bank_mask:0xf
  s_waitcnt vmcnt(4)
  s_nop 0
  v_mfma_f32_16x16x16_bf16 v[32:35], v[14:15], v[128:129], v[32:35]
  v_mfma_f32_16x16x16_bf16 v[36:39], v[14:15], v[130:131], v[36:39]
  v_and_b32_dpp v12, v44, v3 quad_perm:[0,0,0,0] row_mask:0xf bank_mask:0xf
  v_and_b32_dpp v13, v44, v4 quad_perm:[0,0,0,0] row_mask:0xf bank_mask:0xf
  s_waitcnt vmcnt(3)
  s_nop 0
  v_mfma_f32_16x16x16_bf16 v[32:35], v[12:13], v[132:133], v[32:35]
  v_mfma_f32_16x16x16_bf16 v[36:39], v[12:13], v[134:135], v[36:39]
  v_and_b32_dpp v14, v44, v3 quad_perm:[1,1,1,1] row_mask:0xf bank_mask:0xf
  v_and_b32_dpp v15, v44, v4 quad_perm:[1,1,1,1] row_mask:0xf bank_mask:0xf
  s_waitcnt vmcnt(2)
  s_nop 0
  v_mfma_f32_16x16x16_bf16 v[32:35], v[14:15], v[136:137], v[32:35]
  v_mfma_f32_16x16x16_bf16 v[36:39], v[14:15], v[138:139], v[36:39]
  v_and_b32_dpp v12, v44, v3 quad_perm:[2,2,2,2] row_mask:0xf bank_mask:0xf
  v_and_b32_dpp v13, v44, v4 quad_perm:[2,2,2,2] row_mask:0xf bank_mask:0xf
  s_waitcnt vmcnt(1)
  s_nop 0
  v_mfma_f32_16x16x16_bf16 v[32:35], v[12:13], v[140:141], v[32:35]
  v_mfma_f32_16x16x16_bf16 v[36:39], v[12:13], v[142:143], v[36:39]
  v_and_b32_dpp v14, v44, v3 quad_perm:[3,3,3,3] row_mask:0xf bank_mask:0xf
  v_and_b32_dpp v15, v44, v4 quad_perm:[3,3,3,3] row_mask:0xf bank_mask:0xf
  s_waitcnt vmcnt(0)
  s_nop 0
  v_mfma_f32_16x16x16_bf16 v[32:35], v[14:15], v[144:145], v[32:35]
  v_mfma_f32_16x16x16_bf16 v[36:39], v[14:15], v[146:147], v[36:39]
  v_lshrrev_b32 v9, 5, v47
  v_lshlrev_b32 v9, 2, v9
  s_nop 5
  ds_write_b128 v45, v[32:35] offset:8192
  ds_write_b128 v45, v[36:39] offset:8208
  s_waitcnt lgkmcnt(0)
  s_barrier
  ds_read_b128 v[52:55], v47 offset:8192
  ds_read_b128 v[56:59], v47 offset:10240
  ds_read_b32 v10, v9 offset:14336
  ds_read_b128 v[60:63], v47 offset:12288
  s_waitcnt lgkmcnt(2)
  v_add_f32 v52, v52, v56
  v_add_f32 v53, v53, v57
  v_add_f32 v54, v54, v58
  v_add_f32 v55, v55, v59
  s_waitcnt lgkmcnt(0)
  v_fma_f32 v52, v52, v10, v60
  v_fma_f32 v53, v53, v10, v61
  v_fma_f32 v54, v54, v10, v62
  v_fma_f32 v55, v55, v10, v63
  v_cvt_pk_bf16_f32 v52, v52, v53
  v_cvt_pk_bf16_f32 v53, v54, v55
  global_store_dwordx2 v46, v[52:53], s[10:11]
L_done:
  s_endpgm
L_helper:
  s_getreg_b32 s26, hwreg(HW_REG_XCC_ID)
  s_bitcmp0_b32 s26, 0
  s_cselect_b32 s38, 35, 0
  s_add_u32 s38, s38, 275
  v_mov_b32 v1, 69632
  s_lshl_b32 s29, s38, 16
  s_mov_b32 s28, 0
  s_or_b32 s30, s29, s28
  v_mov_b32 v2, s30
  ds_write_b32 v1, v2
  s_lshl_b32 s26, s2, 11
  v_lshl_add_u32 v12, v0, 4, s26
  v_xor_b32 v14, 0x800, v12
  s_lshl_b32 s27, s2, 7
  s_add_u32 s26, s27, 0x80000
  v_lshrrev_b32 v13, 4, v0
  v_lshl_add_u32 v13, v13, 3, s26
  v_xor_b32 v15, 0x80, v13
  s_add_u32 s26, s27, 0x90000
  v_mov_b32 v6, s26
  v_xor_b32 v7, 0x80, v6
  s_mov_b32 s26, 0xa0000
  v_lshl_add_u32 v3, v0, 7, s26
  v_add_u32 v4, 0x2000, v3
  s_and_b32 s20, s27, 0x3f80
  s_add_u32 s20, s20, s26
  s_mov_b32 s16, 0x6650371e
  s_mov_b32 s17, 0x76
  s_mov_b32 s18, 0x50505050
  s_mov_b32 s19, 0x0
  s_mov_b32 s24, 0
  s_mov_b32 s25, 0
  s_mov_b32 s32, 0
  s_mov_b32 s39, 0
  s_lshr_b32 s31, s2, 2
  s_add_u32 s31, s31, 8
  s_waitcnt lgkmcnt(0)
  s_add_u32 s4, s14, s20
  s_addc_u32 s5, s15, 0
  s_load_dword s21, s[4:5], 0 glc
  global_load_dwordx4 v[16:19], v12, s[14:15] sc0 sc1
  global_load_dwordx4 v[20:23], v12, s[14:15] offset:1024 sc0 sc1
  global_load_dwordx2 v[24:25], v13, s[14:15] sc0 sc1
  global_load_dwordx4 v[28:31], v14, s[14:15] sc0 sc1
  global_load_dwordx4 v[32:35], v14, s[14:15] offset:1024 sc0 sc1
  global_load_dwordx2 v[36:37], v15, s[14:15] sc0 sc1
  s_cmp_eq_u32 s2, 5
  s_cselect_b32 s33, 1, 0
  s_cbranch_scc0 L_hnot
  s_load_dword s40, s[14:15], 0xa8000 glc
  s_load_dword s41, s[14:15], 0xa8080 glc
  global_load_dword v5, v3, s[14:15] sc0 sc1
  global_load_dword v11, v4, s[14:15] sc0 sc1
L_hnot:
  s_mov_b64 s[10:11], 0
  s_cmp_eq_u32 s2, 7
  s_cselect_b32 s26, 0xa8000, 0
  s_cmp_eq_u32 s2, 1
  s_cselect_b32 s26, 0xa8080, s26
  v_mov_b32 v86, s26
  s_cmp_eq_u32 s26, 0
  s_cbranch_scc1 L_hng
  s_mov_b64 s[10:11], s[16:17]
  global_load_dword v87, v86, s[14:15] sc0 sc1
L_hng:
L_hloop:
  s_barrier
  s_add_u32 s24, s24, 1
  s_waitcnt vmcnt(0) lgkmcnt(0)
  s_mov_b64 exec, 1
  s_cmp_eq_u32 s24, 1
  s_cbranch_scc0 L_he1
  global_load_dword v8, v6, s[14:15] sc0 sc1
  global_load_dword v9, v7, s[14:15] sc0 sc1
L_he1:
  s_cmp_eq_u32 s24, s31
  s_cbranch_scc0 L_he2
  v_add_u32 v8, 1, v8
  global_store_dword v6, v8, s[14:15] sc0 sc1
L_he2:
  s_cmp_eq_u32 s24, 90
  s_cbranch_scc0 L_he3
  global_load_dword v10, v7, s[14:15] sc0 sc1
L_he3:
  s_cmp_eq_u32 s24, 91
  s_cbranch_scc0 L_he4
  v_cmp_ne_u32 vcc, v9, v10
  s_mov_b32 s39, vcc_lo
L_he4:
  s_and_b32 s30, s10, 0xff
  s_sub_u32 s30, s30, 1
  s_cmp_eq_u32 s30, s24
  s_cbranch_scc0 L_he5
  v_add_u32 v87, 1, v87
  global_store_dword v86, v87, s[14:15] sc0 sc1
  s_lshr_b64 s[10:11], s[10:11], 8
L_he5:
  s_mov_b64 exec, -1
  s_cmp_eq_u32 s24, 1
  s_cbranch_scc1 L_pad_v0
  s_cmp_eq_u32 s24, 2
  s_cbranch_scc1 L_pad_g
L_hpadd:
  s_cmp_eq_u32 s24, 127
  s_cbranch_scc1 L_hpub
L_hpubd:
  s_cmp_eq_u32 s33, 1
  s_cbranch_scc1 L_href
L_hread:
  s_cmp_lg_u32 s32, 0
  s_cbranch_scc1 L_hwait
  s_lshl_b32 s30, s25, 3
  s_lshr_b64 s[22:23], s[16:17], s30
  s_and_b32 s22, s22, 0xff
  s_add_u32 s23, s24, 3
  s_cmp_lt_u32 s23, s22
  s_cbranch_scc1 L_hnext
  s_load_dword s35, s[4:5], 0 glc
  s_waitcnt lgkmcnt(0)
  s_sub_u32 s30, s35, s21
  s_cmp_eq_u32 s30, s25
  s_cbranch_scc1 L_hsame
L_hsaw:
  s_min_u32 s25, s30, 5
  s_lshl_b32 s30, s25, 3
  s_sub_u32 s30, s30, 8
  s_lshr_b64 s[22:23], s[16:17], s30
  s_and_b32 s22, s22, 0xff
  s_sub_i32 s22, s22, s24
  s_add_i32 s22, s22, 1
L_hlate:
  s_cmp_eq_u32 s25, 5
  s_cbranch_scc1 L_hfin
  s_lshr_b64 s[26:27], s[18:19], s30
  s_and_b32 s26, s26, 0xff
  s_mul_i32 s26, s26, s22
  s_add_i32 s30, s38, s26
  s_max_i32 s30, s30, 0
  s_min_i32 s30, s30, 512
  s_lshl_b32 s29, s30, 16
  s_or_b32 s30, s29, s28
  v_mov_b32 v2, s30
  ds_write_b32 v1, v2
L_hsame:
L_hnext:
  s_cmp_eq_u32 s24, 64
  s_cbranch_scc0 L_hnb
  s_barrier
L_hnb:
  s_cmp_lt_u32 s24, 127
  s_cbranch_scc1 L_hloop
  s_branch L_hget
L_hfin:
  s_mul_i32 s22, s22, 6
  s_ashr_i32 s22, s22, 1
  s_sub_i32 s32, s24, s22
  s_add_i32 s32, s32, 4
  s_max_i32 s32, s32, 1
L_hwait:
  s_cmp_lt_i32 s24, s32
  s_cbranch_scc1 L_hnext
  s_mov_b32 s28, 1
  s_or_b32 s30, s29, s28
  v_mov_b32 v2, s30
  ds_write_b32 v1, v2
  s_branch L_hnext
L_href:
  s_cmp_lg_u32 s32, 0
  s_cbranch_scc1 L_hwait
  s_lshl_b32 s30, s25, 3
  s_lshr_b64 s[22:23], s[16:17], s30
  s_and_b32 s22, s22, 0xff
  s_sub_i32 s22, s22, s24
  s_cmp_gt_i32 s22, 0
  s_cbranch_scc1 L_hnext
  s_cmp_le_i32 s22, -3
  s_cbranch_scc1 L_hsay
  s_load_dword s44, s[14:15], 0xa8000 glc
  s_load_dword s45, s[14:15], 0xa8080 glc
  s_waitcnt lgkmcnt(0)
  s_sub_u32 s44, s44, s40
  s_cmp_gt_u32 s44, s25
  s_cbranch_scc0 L_hnext
  s_sub_u32 s45, s45, s41
  s_cmp_gt_u32 s45, s25
  s_cbranch_scc0 L_hnext
L_hsay:
  v_add_u32 v5, 1, v5
  global_store_dword v3, v5, s[14:15] sc0 sc1
  v_add_u32 v11, 1, v11
  global_store_dword v4, v11, s[14:15] sc0 sc1
  s_add_u32 s25, s25, 1
  s_cmp_eq_u32 s25, 5
  s_cbranch_scc0 L_hlate
  s_mul_i32 s22, s22, 6
  s_ashr_i32 s22, s22, 1
  s_sub_i32 s32, s24, s22
  s_add_i32 s32, s32, 3
  s_branch L_hwait
L_hpub:
  v_lshlrev_b32 v2, 5, v0
  ds_read_b128 v[52:55], v2 offset:2048
  ds_read_b128 v[56:59], v2 offset:2064
  ds_read_b128 v[64:67], v2 offset:4096
  ds_read_b128 v[68:71], v2 offset:4112
  v_lshrrev_b32 v2, 4, v0
  v_lshlrev_b32 v2, 5, v2
  ds_read_b64 v[60:61], v2 offset:6144
  ds_read_b64 v[72:73], v2 offset:6656
  v_not_b32 v16, v16
  v_not_b32 v17, v17
  v_not_b32 v18, v18
  v_not_b32 v19, v19
  v_not_b32 v20, v20
  v_not_b32 v21, v21
  v_not_b32 v22, v22
  v_not_b32 v23, v23
  v_not_b32 v24, v24
  v_not_b32 v25, v25
  s_waitcnt lgkmcnt(0)
  v_add_f32 v52, v52, v64
  v_add_f32 v53, v53, v65
  v_add_f32 v54, v54, v66
  v_add_f32 v55, v55, v67
  v_add_f32 v56, v56, v68
  v_add_f32 v57, v57, v69
  v_add_f32 v58, v58, v70
  v_add_f32 v59, v59, v71
  v_add_f32 v61, v61, v73
  v_bfi_b32 v16, 1, v16, v52
  v_bfi_b32 v17, 1, v17, v53
  v_bfi_b32 v18, 1, v18, v54
  v_bfi_b32 v19, 1, v19, v55
  v_bfi_b32 v20, 1, v20, v56
  v_bfi_b32 v21, 1, v21, v57
  v_bfi_b32 v22, 1, v22, v58
  v_bfi_b32 v23, 1, v23, v59
  v_bfi_b32 v24, 1, v24, v60
  v_bfi_b32 v25, 1, v25, v61
  global_store_dwordx4 v12, v[16:19], s[14:15] sc0 sc1
  global_store_dwordx4 v12, v[20:23], s[14:15] offset:1024 sc0 sc1
  s_mov_b32 exec_lo, 0x00010001
  s_mov_b32 exec_hi, 0x00010001
  global_store_dwordx2 v13, v[24:25], s[14:15] sc0 sc1
  s_mov_b64 exec, -1
  s_branch L_hpubd
L_hget:
  s_xor_b32 s26, s2, 1
  v_mov_b32 v9, s26
  s_mov_b32 s25, 0
  s_cmp_lg_u32 s39, 0
  s_cbranch_scc1 L_hpoll
  v_mov_b32 v8, s2
  v_mov_b32 v10, 1
  s_waitcnt vmcnt(0)
  s_mov_b64 exec, 1
  global_store_byte v8, v10, s[12:13] sc0 sc1
  s_mov_b64 exec, -1
L_hpoll:
  s_add_u32 s25, s25, 1
  s_bitcmp1_b32 s25, 23
  s_cbranch_scc1 L_hhave
  s_cmp_lg_u32 s39, 0
  s_cbranch_scc1 L_htag
  global_load_ubyte v76, v9, s[12:13] sc0 sc1
  s_waitcnt vmcnt(0)
  v_cmp_ne_u32 vcc, 0, v76
  s_cbranch_vccz L_htag
  global_load_dwordx4 v[40:43], v14, s[14:15] sc0 sc1
  global_load_dwordx4 v[44:47], v14, s[14:15] offset:1024 sc0 sc1
  global_load_dwordx2 v[48:49], v15, s[14:15] sc0 sc1
  s_waitcnt vmcnt(0)
  s_branch L_hhave
L_htag:
  global_load_dwordx4 v[40:43], v14, s[14:15] sc0 sc1
  global_load_dwordx4 v[44:47], v14, s[14:15] offset:1024 sc0 sc1
  global_load_dwordx2 v[48:49], v15, s[14:15] sc0 sc1
  s_waitcnt vmcnt(0)
  v_xor_b32 v76, v40, v28
  v_xor_b32 v77, v41, v29
  v_xor_b32 v78, v42, v30
  v_xor_b32 v79, v43, v31
  v_xor_b32 v80, v44, v32
  v_xor_b32 v81, v45, v33
  v_xor_b32 v82, v46, v34
  v_xor_b32 v83, v47, v35
  v_xor_b32 v84, v48, v36
  v_xor_b32 v85, v49, v37
  v_and_b32 v76, v76, v81
  v_and_b32 v77, v77, v82
  v_and_b32 v78, v78, v83
  v_and_b32 v79, v79, v84
  v_and_b32 v80, v80, v85
  v_and_b32 v76, v76, v77
  v_and_b32 v78, v78, v79
  v_and_b32 v76, v76, v80
  v_and_b32 v76, v76, v78
  v_and_b32 v76, 1, v76
  v_cmp_eq_u32 vcc, 0, v76
  s_cbranch_vccnz L_hpoll
L_hhave:
  v_and_b32 v40, -2, v40
  v_and_b32 v41, -2, v41
  v_and_b32 v42, -2, v42
  v_and_b32 v43, -2, v43
  v_and_b32 v44, -2, v44
  v_and_b32 v45, -2, v45
  v_and_b32 v46, -2, v46
  v_and_b32 v47, -2, v47
  v_and_b32 v48, -2, v48
  v_and_b32 v49, -2, v49
  v_min_f32 v2, v60, v48
  v_sub_f32 v60, v2, v60
  v_sub_f32 v48, v2, v48
  v_exp_f32 v60, v60
  v_exp_f32 v48, v48
  v_lshlrev_b32 v3, 5, v0
  v_mul_f32 v2, v60, v61
  v_fmac_f32 v2, v48, v49
  v_rcp_f32 v2, v2
  v_lshlrev_b32 v4, 2, v0
  v_mul_f32 v60, v60, v2
  v_mul_f32 v48, v48, v2
  v_mul_f32 v40, v48, v40
  v_mul_f32 v41, v48, v41
  v_mul_f32 v42, v48, v42
  v_mul_f32 v43, v48, v43
  v_mul_f32 v44, v48, v44
  v_mul_f32 v45, v48, v45
  v_mul_f32 v46, v48, v46
  v_mul_f32 v47, v48, v47
  ds_write_b32 v4, v60 offset:14336
  ds_write_b128 v3, v[40:43] offset:12288
  ds_write_b128 v3, v[44:47] offset:12304
  s_waitcnt lgkmcnt(0)
  s_barrier
  s_endpgm
L_glue1:
  s_cmp_eq_u32 s39, 2
  s_mov_b32 s39, 0
  s_cbranch_scc1 L_dump1
  v_cndmask_b32 v7, v7, 0, s[44:45]
  s_nop 3
  v_cndmask_b32 v52, 0, v32, s[44:45]
  v_cndmask_b32 v53, 0, v33, s[44:45]
  v_cndmask_b32 v54, 0, v34, s[44:45]
  v_cndmask_b32 v55, 0, v35, s[44:45]
  v_cndmask_b32 v56, 0, v36, s[44:45]
  v_cndmask_b32 v57, 0, v37, s[44:45]
  v_cndmask_b32 v58, 0, v38, s[44:45]
  v_cndmask_b32 v59, 0, v39, s[44:45]
  v_cndmask_b32 v32, v32, 0, s[44:45]
  v_cndmask_b32 v33, v33, 0, s[44:45]
  v_cndmask_b32 v34, v34, 0, s[44:45]
  v_cndmask_b32 v35, v35, 0, s[44:45]
  v_cndmask_b32 v36, v36, 0, s[44:45]
  v_cndmask_b32 v37, v37, 0, s[44:45]
  v_cndmask_b32 v38, v38, 0, s[44:45]
  v_cndmask_b32 v39, v39, 0, s[44:45]
  s_nop 0
  s_branch L_back1
L_dump1:
  v_add_f32_dpp v9, v7, v7 quad_perm:[1,0,3,2] row_mask:0xf bank_mask:0xf
  s_nop 1
  v_add_f32_dpp v9, v9, v9 quad_perm:[2,3,0,1] row_mask:0xf bank_mask:0xf
  v_mov_b32 v10, v9
  ds_write_b128 v45, v[32:35] offset:2048
  ds_write_b128 v45, v[36:39] offset:2064
  v_permlane32_swap_b32 v9, v10
  v_add_f32 v9, v9, v10
  v_mov_b32 v10, v9
  s_nop 1
  v_permlane16_swap_b32 v9, v10
  v_add_f32 v49, v9, v10
  v_mov_b32 v48, v6
  v_lshrrev_b32 v9, 2, v45
  ds_write_b64 v9, v[48:49] offset:6144
  s_waitcnt lgkmcnt(0)
  v_mov_b32 v32, v52
  v_mov_b32 v33, v53
  v_mov_b32 v34, v54
  v_mov_b32 v35, v55
  v_mov_b32 v36, v56
  v_mov_b32 v37, v57
  v_mov_b32 v38, v58
  v_mov_b32 v39, v59
  s_nop 0
  s_branch L_back1
L_glue2:
  s_cmp_eq_u32 s39, 2
  s_mov_b32 s39, 0
  s_cbranch_scc1 L_dump2
  v_cndmask_b32 v7, v7, 0, s[44:45]
  s_nop 3
  v_cndmask_b32 v52, 0, v32, s[44:45]
  v_cndmask_b32 v53, 0, v33, s[44:45]
  v_cndmask_b32 v54, 0, v34, s[44:45]
  v_cndmask_b32 v55, 0, v35, s[44:45]
  v_cndmask_b32 v56, 0, v36, s[44:45]
  v_cndmask_b32 v57, 0, v37, s[44:45]
  v_cndmask_b32 v58, 0, v38, s[44:45]
  v_cndmask_b32 v59, 0, v39, s[44:45]
  v_cndmask_b32 v32, v32, 0, s[44:45]
  v_cndmask_b32 v33, v33, 0, s[44:45]
  v_cndmask_b32 v34, v34, 0, s[44:45]
  v_cndmask_b32 v35, v35, 0, s[44:45]
  v_cndmask_b32 v36, v36, 0, s[44:45]
  v_cndmask_b32 v37, v37, 0, s[44:45]
  v_cndmask_b32 v38, v38, 0, s[44:45]
  v_cndmask_b32 v39, v39, 0, s[44:45]
  s_nop 0
  s_branch L_back2
L_dump2:
  v_add_f32_dpp v9, v7, v7 quad_perm:[1,0,3,2] row_mask:0xf bank_mask:0xf
  s_nop 1
  v_add_f32_dpp v9, v9, v9 quad_perm:[2,3,0,1] row_mask:0xf bank_mask:0xf
  v_mov_b32 v10, v9
  ds_write_b128 v45, v[32:35] offset:2048
  ds_write_b128 v45, v[36:39] offset:2064
  v_permlane32_swap_b32 v9, v10
  v_add_f32 v9, v9, v10
  v_mov_b32 v10, v9
  s_nop 1
  v_permlane16_swap_b32 v9, v10
  v_add_f32 v49, v9, v10
  v_mov_b32 v48, v6
  v_lshrrev_b32 v9, 2, v45
  ds_write_b64 v9, v[48:49] offset:6144
  s_waitcnt lgkmcnt(0)
  v_mov_b32 v32, v52
  v_mov_b32 v33, v53
  v_mov_b32 v34, v54
  v_mov_b32 v35, v55
  v_mov_b32 v36, v56
  v_mov_b32 v37, v57
  v_mov_b32 v38, v58
  v_mov_b32 v39, v59
  s_nop 0
  s_branch L_back2
L_glue3:
  s_cmp_eq_u32 s39, 2
  s_mov_b32 s39, 0
  s_cbranch_scc1 L_dump3
  v_cndmask_b32 v7, v7, 0, s[44:45]
  s_nop 3
  v_cndmask_b32 v52, 0, v32, s[44:45]
  v_cndmask_b32 v53, 0, v33, s[44:45]
  v_cndmask_b32 v54, 0, v34, s[44:45]
  v_cndmask_b32 v55, 0, v35, s[44:45]
  v_cndmask_b32 v56, 0, v36, s[44:45]
  v_cndmask_b32 v57, 0, v37, s[44:45]
  v_cndmask_b32 v58, 0, v38, s[44:45]
  v_cndmask_b32 v59, 0, v39, s[44:45]
  v_cndmask_b32 v32, v32, 0, s[44:45]
  v_cndmask_b32 v33, v33, 0, s[44:45]
  v_cndmask_b32 v34, v34, 0, s[44:45]
  v_cndmask_b32 v35, v35, 0, s[44:45]
  v_cndmask_b32 v36, v36, 0, s[44:45]
  v_cndmask_b32 v37, v37, 0, s[44:45]
  v_cndmask_b32 v38, v38, 0, s[44:45]
  v_cndmask_b32 v39, v39, 0, s[44:45]
  s_nop 0
  s_branch L_back3
L_dump3:
  v_add_f32_dpp v9, v7, v7 quad_perm:[1,0,3,2] row_mask:0xf bank_mask:0xf
  s_nop 1
  v_add_f32_dpp v9, v9, v9 quad_perm:[2,3,0,1] row_mask:0xf bank_mask:0xf
  v_mov_b32 v10, v9
  ds_write_b128 v45, v[32:35] offset:2048
  ds_write_b128 v45, v[36:39] offset:2064
  v_permlane32_swap_b32 v9, v10
  v_add_f32 v9, v9, v10
  v_mov_b32 v10, v9
  s_nop 1
  v_permlane16_swap_b32 v9, v10
  v_add_f32 v49, v9, v10
  v_mov_b32 v48, v6
  v_lshrrev_b32 v9, 2, v45
  ds_write_b64 v9, v[48:49] offset:6144
  s_waitcnt lgkmcnt(0)
  v_mov_b32 v32, v52
  v_mov_b32 v33, v53
  v_mov_b32 v34, v54
  v_mov_b32 v35, v55
  v_mov_b32 v36, v56
  v_mov_b32 v37, v57
  v_mov_b32 v38, v58
  v_mov_b32 v39, v59
  s_nop 0
  s_branch L_back3
L_glue4:
  s_cmp_eq_u32 s39, 2
  s_mov_b32 s39, 0
  s_cbranch_scc1 L_dump4
  v_cndmask_b32 v7, v7, 0, s[44:45]
  s_nop 3
  v_cndmask_b32 v52, 0, v32, s[44:45]
  v_cndmask_b32 v53, 0, v33, s[44:45]
  v_cndmask_b32 v54, 0, v34, s[44:45]
  v_cndmask_b32 v55, 0, v35, s[44:45]
  v_cndmask_b32 v56, 0, v36, s[44:45]
  v_cndmask_b32 v57, 0, v37, s[44:45]
  v_cndmask_b32 v58, 0, v38, s[44:45]
  v_cndmask_b32 v59, 0, v39, s[44:45]
  v_cndmask_b32 v32, v32, 0, s[44:45]
  v_cndmask_b32 v33, v33, 0, s[44:45]
  v_cndmask_b32 v34, v34, 0, s[44:45]
  v_cndmask_b32 v35, v35, 0, s[44:45]
  v_cndmask_b32 v36, v36, 0, s[44:45]
  v_cndmask_b32 v37, v37, 0, s[44:45]
  v_cndmask_b32 v38, v38, 0, s[44:45]
  v_cndmask_b32 v39, v39, 0, s[44:45]
  s_nop 0
  s_branch L_back4
L_dump4:
  v_add_f32_dpp v9, v7, v7 quad_perm:[1,0,3,2] row_mask:0xf bank_mask:0xf
  s_nop 1
  v_add_f32_dpp v9, v9, v9 quad_perm:[2,3,0,1] row_mask:0xf bank_mask:0xf
  v_mov_b32 v10, v9
  ds_write_b128 v45, v[32:35] offset:2048
  ds_write_b128 v45, v[36:39] offset:2064
  v_permlane32_swap_b32 v9, v10
  v_add_f32 v9, v9, v10
  v_mov_b32 v10, v9
  s_nop 1
  v_permlane16_swap_b32 v9, v10
  v_add_f32 v49, v9, v10
  v_mov_b32 v48, v6
  v_lshrrev_b32 v9, 2, v45
  ds_write_b64 v9, v[48:49] offset:6144
  s_waitcnt lgkmcnt(0)
  v_mov_b32 v32, v52
  v_mov_b32 v33, v53
  v_mov_b32 v34, v54
  v_mov_b32 v35, v55
  v_mov_b32 v36, v56
  v_mov_b32 v37, v57
  v_mov_b32 v38, v58
  v_mov_b32 v39, v59
  s_nop 0
  s_branch L_back4
L_pad_g:
  s_branch L_hpadd
.section .rodata,"a"
.p2align 6
.amdhsa_kernel standalone__softmax_full_bidir__sampling_kernel
  .amdhsa_next_free_vgpr 148
  .amdhsa_next_free_sgpr 48
  .amdhsa_accum_offset 148
  .amdhsa_group_segment_fixed_size 0
  .amdhsa_kernarg_size 48
  .amdhsa_user_sgpr_count 2
  .amdhsa_user_sgpr_kernarg_segment_ptr 1
  .amdhsa_system_sgpr_workgroup_id_x 1
  .amdhsa_float_denorm_mode_32 3
.end_amdhsa_kernel
```
